```python
import torch

def _softmax(x, axis=-1):
    return torch.softmax(x, dim=axis)
def _gelu(x):
    return torch.nn.functional.gelu(x, approximate="tanh")
def _silu(x):
    return torch.nn.functional.silu(x)
def _sigmoid(x):
    return torch.sigmoid(x)
def _layernorm(x, axis=-1, eps=1e-5):
    m = x.mean(dim=axis, keepdim=True)
    v = x.var(dim=axis, keepdim=True, unbiased=False)
    return (x - m) / torch.sqrt(v + eps)
def _scatter_add(tgt, idx, src, axis=0):
    return tgt.clone().index_add_(axis, idx, src)
def _segment_sum(src, seg, n):
    out = torch.zeros((n,) + src.shape[1:], dtype=src.dtype)
    return out.index_add_(0, seg, src)
def _pad(x, pw):
    flat = tuple(v for pair in reversed(pw) for v in pair)
    return torch.nn.functional.pad(x, flat)

kernel_name = 'standalone__mha_block_cached__near_ridge'

def setup_inputs():

    _w = (lambda a: (lambda t: t.to(torch.bfloat16) if t.is_floating_point() else t)(torch.as_tensor(a)))
    B, Sq, D = 8, 128, 1024
    H, Sk, Dh = 32, 1024, 128
    return {
        "x": _w((lambda *s: torch.randn(*s, dtype=torch.bfloat16) * 0.8)(B, Sq, D)),
        "k_cache": _w((lambda *s: torch.randn(*s, dtype=torch.bfloat16) * 0.8)(B, H, Sk, Dh)),
        "v_cache": _w((lambda *s: torch.randn(*s, dtype=torch.bfloat16) * 0.05)(B, H, Sk, Dh)),
        "wq": _w((lambda *s: torch.randn(*s, dtype=torch.bfloat16) * 0.8)(D, H * Dh) * (D ** -0.5)),
        "wo": _w((lambda *s: torch.randn(*s, dtype=torch.bfloat16) * 0.05)(H * Dh, D) * ((H * Dh) ** -0.5)),
    }

def reference(x, k_cache, v_cache, wq, wo):
    B, Sq, D = x.shape
    H, Dh = 32, 128
    q = (lambda x, *d: x.permute(*d))((x @ wq).reshape(B, Sq, H, Dh), 0, 2, 1, 3)
    scores = torch.einsum("bhqd,bhkd->bhqk", q, k_cache) * (Dh ** -0.5)
    p = _softmax(scores, axis=-1)
    o = torch.einsum("bhqk,bhkd->bhqd", p, v_cache)
    return (lambda x, *d: x.permute(*d))(o, 0, 2, 1, 3).reshape(B, Sq, H * Dh) @ wo
```

```asm
; @launch grid=(256,1,1) block=(512,1,1) lds=163840
.amdgcn_target "amdgcn-amd-amdhsa--gfx950"
.text
.globl standalone__mha_block_cached__near_ridge_kernel
.p2align 8
.type standalone__mha_block_cached__near_ridge_kernel,@function
standalone__mha_block_cached__near_ridge_kernel:
    s_cmp_ge_u32 s2, 256
    s_cbranch_scc1 L1_end
    s_load_dwordx8 s[4:11], s[0:1], 0
    s_load_dwordx2 s[18:19], s[0:1], 56
    s_load_dwordx2 s[26:27], s[0:1], 32
    v_and_b32 v1, 63, v0
    v_lshrrev_b32 v2, 6, v0
    s_and_b32 s44, s2, 7
    s_lshr_b32 s45, s2, 3
    v_readfirstlane_b32 s40, v2
    s_and_b32 s46, s45, 3
    s_lshl_b32 s44, s44, 2
    s_add_u32 s42, s44, s46
    s_lshr_b32 s41, s45, 2
    s_mov_b32 s44, s41
    s_and_b32 s43, s44, 15
    s_and_b32 s20, s40, 3
    s_lshr_b32 s21, s40, 2
    s_mov_b32 s25, 0
    s_lshl_b32 s23, s21, 13
    v_lshrrev_b32 v3, 4, v1
    v_and_b32 v4, 15, v1
    v_lshlrev_b32 v5, 2, v3
    v_xor_b32 v5, v4, v5
    v_lshlrev_b32 v5, 4, v5
    s_cmp_eq_u32 s20, 1
    s_cbranch_scc1 L1_rx
    s_cmp_eq_u32 s20, 2
    s_cbranch_scc1 L1_rk
    s_cmp_eq_u32 s20, 3
    s_cbranch_scc1 L1_rv
    v_lshl_or_b32 v26, v3, 13, v5
    v_mov_b32 v27, v26
    v_mov_b32 v28, v26
    v_mov_b32 v29, v26
    s_mov_b32 s16, 31744
    s_mov_b32 s17, 524288
    s_mov_b32 s55, 0
    s_lshl_b32 s24, s21, 18
    s_lshl_b32 s44, s42, 8
    s_waitcnt lgkmcnt(0)
    s_add_u32 s12, s10, s44
    s_addc_u32 s13, s11, 0
    s_and_b32 s13, s13, 0xffff
    s_sub_u32 s14, 0x800000, s44
    s_mov_b32 s15, 0x20000
    s_mov_b64 vcc, -1
    s_branch L1_rdone
L1_rx:
    v_lshrrev_b32 v2, 3, v1
    v_and_b32 v4, 7, v1
    v_xor_b32 v4, v4, v3
    v_lshlrev_b32 v2, 11, v2
    v_lshl_or_b32 v26, v4, 4, v2
    v_xor_b32 v27, 64, v26
    v_mov_b32 v28, v26
    v_mov_b32 v29, v27
    s_mov_b32 s16, 15360
    s_mov_b32 s17, 128
    s_mov_b32 s55, 1
    s_lshl_b32 s24, s21, 17
    s_lshl_b32 s44, s41, 18
    s_waitcnt lgkmcnt(0)
    s_add_u32 s12, s4, s44
    s_addc_u32 s13, s5, 0
    s_and_b32 s13, s13, 0xffff
    s_mov_b32 s14, 0x40000
    s_mov_b32 s15, 0x20000
    s_mov_b64 vcc, -1
    s_branch L1_rdone
L1_rk:
    v_xor_b32 v2, v4, v3
    v_lshlrev_b32 v2, 4, v2
    v_lshl_or_b32 v26, v3, 8, v2
    v_xor_b32 v27, 64, v26
    v_xor_b32 v28, 128, v26
    v_xor_b32 v29, 192, v26
    s_mov_b32 s16, 0
    s_mov_b32 s17, 0
    s_add_u32 s55, s23, 0
    s_mov_b32 s24, s23
    s_lshl_b32 s44, s41, 5
    s_add_u32 s44, s44, s42
    s_lshl_b32 s44, s44, 18
    s_waitcnt lgkmcnt(0)
    s_add_u32 s12, s6, s44
    s_addc_u32 s13, s7, 0
    s_and_b32 s13, s13, 0xffff
    s_mov_b32 s14, 0x40000
    s_mov_b32 s15, 0x20000
    s_mov_b64 vcc, 0
    s_branch L1_rdone
L1_rv:
    v_lshl_or_b32 v26, v3, 8, v5
    v_mov_b32 v27, v26
    v_mov_b32 v28, v26
    v_mov_b32 v29, v26
    s_mov_b32 s16, 0
    s_mov_b32 s17, 0
    s_add_u32 s55, s23, 49152
    s_mov_b32 s24, s23
    s_lshl_b32 s44, s41, 5
    s_add_u32 s44, s44, s42
    s_lshl_b32 s44, s44, 18
    s_waitcnt lgkmcnt(0)
    s_add_u32 s12, s8, s44
    s_addc_u32 s13, s9, 0
    s_and_b32 s13, s13, 0xffff
    s_mov_b32 s14, 0x40000
    s_mov_b32 s15, 0x20000
    s_mov_b64 vcc, 0
L1_rdone:
    s_cbranch_vccz L1_q1
    s_add_u32 s44, s43, 0
    s_and_b32 s44, s44, 15
    s_mul_i32 s45, s44, s17
    s_add_u32 s45, s45, s24
    s_mul_i32 s47, s55, 16384
    s_add_u32 s47, s47, s23
    s_add_u32 s46, s47, 98304
    s_mov_b32 m0, s46
    s_cmp_eq_u32 s20, 1
    s_cbranch_scc1 L1_q1x
    s_nop 0
    buffer_load_dwordx4 v26, s[12:15], s45 offen offset:0 nt lds
    s_add_u32 s45, s45, s16
    buffer_load_dwordx4 v27, s[12:15], s45 offen offset:1024 nt lds
    s_add_u32 s45, s45, s16
    buffer_load_dwordx4 v28, s[12:15], s45 offen offset:2048 nt lds
    s_add_u32 s45, s45, s16
    buffer_load_dwordx4 v29, s[12:15], s45 offen offset:3072 nt lds
    s_branch L1_q1
L1_q1x:
    s_nop 0
    buffer_load_dwordx4 v26, s[12:15], s45 offen offset:0 lds
    s_add_u32 s45, s45, s16
    buffer_load_dwordx4 v27, s[12:15], s45 offen offset:1024 lds
    s_add_u32 s45, s45, s16
    buffer_load_dwordx4 v28, s[12:15], s45 offen offset:2048 lds
    s_add_u32 s45, s45, s16
    buffer_load_dwordx4 v29, s[12:15], s45 offen offset:3072 lds
L1_q1:
    s_cbranch_vccz L1_q2
    s_add_u32 s46, s47, 102400
    s_mov_b32 m0, s46
    s_cmp_eq_u32 s20, 1
    s_cbranch_scc1 L1_q2x
    s_add_u32 s45, s45, s16
    s_add_u32 s45, s45, 4096
    buffer_load_dwordx4 v26, s[12:15], s45 offen offset:0 nt lds
    s_add_u32 s45, s45, s16
    buffer_load_dwordx4 v27, s[12:15], s45 offen offset:1024 nt lds
    s_add_u32 s45, s45, s16
    buffer_load_dwordx4 v28, s[12:15], s45 offen offset:2048 nt lds
    s_add_u32 s45, s45, s16
    buffer_load_dwordx4 v29, s[12:15], s45 offen offset:3072 nt lds
    s_branch L1_q2
L1_q2x:
    s_add_u32 s45, s45, s16
    s_add_u32 s45, s45, 4096
    buffer_load_dwordx4 v26, s[12:15], s45 offen offset:0 lds
    s_add_u32 s45, s45, s16
    buffer_load_dwordx4 v27, s[12:15], s45 offen offset:1024 lds
    s_add_u32 s45, s45, s16
    buffer_load_dwordx4 v28, s[12:15], s45 offen offset:2048 lds
    s_add_u32 s45, s45, s16
    buffer_load_dwordx4 v29, s[12:15], s45 offen offset:3072 lds
L1_q2:
    s_cbranch_vccz L1_q3
    s_add_u32 s44, s43, 1
    s_and_b32 s44, s44, 15
    s_mul_i32 s45, s44, s17
    s_add_u32 s45, s45, s24
    s_mul_i32 s47, s55, 49152
    s_add_u32 s47, s47, s23
    s_add_u32 s46, s47, 0
    s_mov_b32 m0, s46
    s_cmp_eq_u32 s20, 1
    s_cbranch_scc1 L1_q3x
    s_nop 0
    buffer_load_dwordx4 v26, s[12:15], s45 offen offset:0 nt lds
    s_add_u32 s45, s45, s16
    buffer_load_dwordx4 v27, s[12:15], s45 offen offset:1024 nt lds
    s_add_u32 s45, s45, s16
    buffer_load_dwordx4 v28, s[12:15], s45 offen offset:2048 nt lds
    s_add_u32 s45, s45, s16
    buffer_load_dwordx4 v29, s[12:15], s45 offen offset:3072 nt lds
    s_branch L1_q3
L1_q3x:
    s_nop 0
    buffer_load_dwordx4 v26, s[12:15], s45 offen offset:0 lds
    s_add_u32 s45, s45, s16
    buffer_load_dwordx4 v27, s[12:15], s45 offen offset:1024 lds
    s_add_u32 s45, s45, s16
    buffer_load_dwordx4 v28, s[12:15], s45 offen offset:2048 lds
    s_add_u32 s45, s45, s16
    buffer_load_dwordx4 v29, s[12:15], s45 offen offset:3072 lds
L1_q3:
    s_cbranch_vccz L1_q4
    s_add_u32 s46, s47, 4096
    s_mov_b32 m0, s46
    s_cmp_eq_u32 s20, 1
    s_cbranch_scc1 L1_q4x
    s_add_u32 s45, s45, s16
    s_add_u32 s45, s45, 4096
    buffer_load_dwordx4 v26, s[12:15], s45 offen offset:0 nt lds
    s_add_u32 s45, s45, s16
    buffer_load_dwordx4 v27, s[12:15], s45 offen offset:1024 nt lds
    s_add_u32 s45, s45, s16
    buffer_load_dwordx4 v28, s[12:15], s45 offen offset:2048 nt lds
    s_add_u32 s45, s45, s16
    buffer_load_dwordx4 v29, s[12:15], s45 offen offset:3072 nt lds
    s_branch L1_q4
L1_q4x:
    s_add_u32 s45, s45, s16
    s_add_u32 s45, s45, 4096
    buffer_load_dwordx4 v26, s[12:15], s45 offen offset:0 lds
    s_add_u32 s45, s45, s16
    buffer_load_dwordx4 v27, s[12:15], s45 offen offset:1024 lds
    s_add_u32 s45, s45, s16
    buffer_load_dwordx4 v28, s[12:15], s45 offen offset:2048 lds
    s_add_u32 s45, s45, s16
    buffer_load_dwordx4 v29, s[12:15], s45 offen offset:3072 lds
L1_q4:
    v_lshlrev_b32 v13, 7, v1
    s_and_b32 s44, s20, 1
    s_lshl_b32 s45, s21, 1
    s_add_u32 s44, s44, s45
    s_lshl_b32 s44, s44, 13
    s_lshl_b32 s45, s2, 15
    s_add_u32 s54, s44, s45
    s_mov_b32 s52, 0x41f00000
    s_mov_b32 s53, 0x3e0293ee
    s_getpc_b64 s[56:57]
L1_pc:
    s_add_u32 s58, s56, L1_rare1-L1_pc
    s_addc_u32 s59, s57, 0
    s_add_u32 s56, s56, L1_rare0-L1_pc
    s_addc_u32 s57, s57, 0
    s_lshl_b32 s22, s40, 11
    s_lshl_b32 s44, s41, 5
    s_add_u32 s44, s44, s42
    s_lshl_b32 s44, s44, 18
    s_add_u32 s28, s6, s44
    s_addc_u32 s29, s7, 0
    s_and_b32 s29, s29, 0xffff
    s_mov_b32 s30, 0x40000
    s_mov_b32 s31, 0x20000
    s_add_u32 s32, s8, s44
    s_addc_u32 s33, s9, 0
    s_and_b32 s33, s33, 0xffff
    s_mov_b32 s34, 0x40000
    s_mov_b32 s35, 0x20000
    s_lshl_b32 s44, s41, 7
    s_add_u32 s44, s44, s42
    s_lshl_b32 s44, s44, 13
    s_add_u32 s36, s18, s44
    s_addc_u32 s37, s19, 0
    s_and_b32 s37, s37, 0xffff
    s_mov_b32 s38, 0xc2000
    s_mov_b32 s39, 0x20000
    v_lshrrev_b32 v3, 4, v1
    v_and_b32 v4, 15, v1
    s_lshl_b32 s44, s40, 3
    v_add_u32 v5, s44, v3
    v_and_b32 v2, 15, v5
    v_xor_b32 v2, v4, v2
    v_lshlrev_b32 v2, 4, v2
    v_lshl_or_b32 v10, v5, 8, v2
    v_xor_b32 v11, 64, v10
    v_lshlrev_b32 v3, 2, v3
    v_xor_b32 v2, v4, v3
    v_lshlrev_b32 v2, 4, v2
    v_lshl_or_b32 v12, v5, 8, v2
    v_lshrrev_b32 v2, 5, v1
    v_bfe_u32 v3, v1, 2, 2
    v_bfe_u32 v4, v1, 4, 1
    v_lshlrev_b32 v4, 5, v4
    v_and_b32 v5, 1, v1
    v_lshl_or_b32 v4, v5, 4, v4
    v_bfe_u32 v5, v1, 1, 1
    v_lshl_or_b32 v4, v5, 3, v4
    v_lshl_or_b32 v4, v3, 8, v4
    v_lshl_or_b32 v4, v3, 6, v4
    v_lshl_or_b32 v22, v2, 10, v4
    s_add_u32 s44, s23, 49152
    v_add_u32 v22, s44, v22
    v_xor_b32 v23, 64, v22
    v_xor_b32 v24, 128, v22
    v_xor_b32 v25, 192, v22
    v_lshl_or_b32 v64, v2, 11, v4
    s_lshl_b32 s44, s21, 7
    v_xor_b32 v64, s44, v64
    v_xor_b32 v65, 64, v64
    v_and_b32 v3, 15, v1
    v_xor_b32 v3, v3, v2
    v_and_b32 v4, 31, v1
    v_lshlrev_b32 v5, 8, v4
    v_lshl_or_b32 v14, v3, 4, v5
    v_add_u32 v14, s23, v14
    v_xor_b32 v15, 32, v14
    v_xor_b32 v16, 64, v14
    v_xor_b32 v17, 96, v14
    v_xor_b32 v18, 128, v14
    v_xor_b32 v19, 160, v14
    v_xor_b32 v20, 192, v14
    v_xor_b32 v21, 224, v14
    v_bfe_u32 v3, v1, 1, 3
    v_xor_b32 v3, v3, v2
    v_lshlrev_b32 v4, 7, v4
    v_lshl_or_b32 v4, v3, 4, v4
    s_lshl_b32 s44, s20, 12
    v_add_u32 v66, s44, v4
    v_xor_b32 v67, 32, v66
    v_xor_b32 v68, 64, v66
    v_xor_b32 v69, 96, v66
    v_add_u32 v70, 65536, v64
    v_add_u32 v71, 65536, v65
    v_add_u32 v72, 65536, v66
    v_add_u32 v73, 65536, v67
    v_add_u32 v74, 65536, v68
    v_add_u32 v75, 65536, v69
    v_add_u32 v76, 131072, v64
    v_add_u32 v77, 131072, v65
    v_add_u32 v78, 131072, v66
    v_add_u32 v79, 131072, v67
    v_add_u32 v80, 131072, v68
    v_add_u32 v81, 131072, v69
    s_lshl_b32 s44, s20, 18
    s_lshl_b32 s45, s21, 12
    s_add_u32 s44, s44, s45
    v_lshlrev_b32 v31, 4, v1
    v_add_u32 v9, s44, v31
    s_cbranch_vccz L1_q5
    s_waitcnt vmcnt(8)
L1_q5:
    s_barrier
    ds_read_b128 a[112:115], v72 offset:49152
    ds_read_b64_tr_b16 a[96:97], v70 offset:32768
    ds_read_b64_tr_b16 a[98:99], v70 offset:33792
    ds_read_b64_tr_b16 a[100:101], v71 offset:32768
    ds_read_b64_tr_b16 a[102:103], v71 offset:33792
    s_waitcnt lgkmcnt(2)
    v_mfma_f32_32x32x16_bf16 v[32:47], a[96:99], a[112:115], 0
    ds_read_b128 a[116:119], v73 offset:49152
    s_cbranch_vccz L1_q6
    s_add_u32 s44, s43, 2
    s_and_b32 s44, s44, 15
    s_mul_i32 s45, s44, s17
    s_add_u32 s45, s45, s24
    s_mul_i32 s47, s55, 49152
    s_add_u32 s47, s47, s23
    s_add_u32 s46, s47, 16384
    s_mov_b32 m0, s46
    s_cmp_eq_u32 s20, 1
    s_cbranch_scc1 L1_q6x
    s_nop 0
    buffer_load_dwordx4 v26, s[12:15], s45 offen offset:0 nt lds
    s_add_u32 s45, s45, s16
    buffer_load_dwordx4 v27, s[12:15], s45 offen offset:1024 nt lds
    s_add_u32 s45, s45, s16
    buffer_load_dwordx4 v28, s[12:15], s45 offen offset:2048 nt lds
    s_add_u32 s45, s45, s16
    buffer_load_dwordx4 v29, s[12:15], s45 offen offset:3072 nt lds
    s_branch L1_q6
L1_q6x:
    s_nop 0
    buffer_load_dwordx4 v26, s[12:15], s45 offen offset:0 lds
    s_add_u32 s45, s45, s16
    buffer_load_dwordx4 v27, s[12:15], s45 offen offset:1024 lds
    s_add_u32 s45, s45, s16
    buffer_load_dwordx4 v28, s[12:15], s45 offen offset:2048 lds
    s_add_u32 s45, s45, s16
    buffer_load_dwordx4 v29, s[12:15], s45 offen offset:3072 lds
L1_q6:
    ds_read_b64_tr_b16 a[104:105], v70 offset:36864
    ds_read_b64_tr_b16 a[106:107], v70 offset:37888
    s_waitcnt lgkmcnt(3)
    v_mfma_f32_32x32x16_bf16 v[48:63], a[100:103], a[112:115], 0
    s_cbranch_vccz L1_q7
    s_add_u32 s46, s47, 20480
    s_mov_b32 m0, s46
    s_cmp_eq_u32 s20, 1
    s_cbranch_scc1 L1_q7x
    s_add_u32 s45, s45, s16
    s_add_u32 s45, s45, 4096
    buffer_load_dwordx4 v26, s[12:15], s45 offen offset:0 nt lds
    s_add_u32 s45, s45, s16
    buffer_load_dwordx4 v27, s[12:15], s45 offen offset:1024 nt lds
    s_add_u32 s45, s45, s16
    buffer_load_dwordx4 v28, s[12:15], s45 offen offset:2048 nt lds
    s_add_u32 s45, s45, s16
    buffer_load_dwordx4 v29, s[12:15], s45 offen offset:3072 nt lds
    s_branch L1_q7
L1_q7x:
    s_add_u32 s45, s45, s16
    s_add_u32 s45, s45, 4096
    buffer_load_dwordx4 v26, s[12:15], s45 offen offset:0 lds
    s_add_u32 s45, s45, s16
    buffer_load_dwordx4 v27, s[12:15], s45 offen offset:1024 lds
    s_add_u32 s45, s45, s16
    buffer_load_dwordx4 v28, s[12:15], s45 offen offset:2048 lds
    s_add_u32 s45, s45, s16
    buffer_load_dwordx4 v29, s[12:15], s45 offen offset:3072 lds
L1_q7:
    ds_read_b64_tr_b16 a[108:109], v71 offset:36864
    ds_read_b64_tr_b16 a[110:111], v71 offset:37888
    s_waitcnt lgkmcnt(2)
    v_mfma_f32_32x32x16_bf16 v[32:47], a[104:107], a[116:119], v[32:47]
    ds_read_b128 a[112:115], v74 offset:49152
    s_cbranch_vccz L1_q8
    s_add_u32 s44, s43, 3
    s_and_b32 s44, s44, 15
    s_mul_i32 s45, s44, s17
    s_add_u32 s45, s45, s24
    s_mul_i32 s47, s55, 49152
    s_add_u32 s47, s47, s23
    s_add_u32 s46, s47, 32768
    s_mov_b32 m0, s46
    s_cmp_eq_u32 s20, 1
    s_cbranch_scc1 L1_q8x
    s_nop 0
    buffer_load_dwordx4 v26, s[12:15], s45 offen offset:0 nt lds
    s_add_u32 s45, s45, s16
    buffer_load_dwordx4 v27, s[12:15], s45 offen offset:1024 nt lds
    s_add_u32 s45, s45, s16
    buffer_load_dwordx4 v28, s[12:15], s45 offen offset:2048 nt lds
    s_add_u32 s45, s45, s16
    buffer_load_dwordx4 v29, s[12:15], s45 offen offset:3072 nt lds
    s_branch L1_q8
L1_q8x:
    s_nop 0
    buffer_load_dwordx4 v26, s[12:15], s45 offen offset:0 lds
    s_add_u32 s45, s45, s16
    buffer_load_dwordx4 v27, s[12:15], s45 offen offset:1024 lds
    s_add_u32 s45, s45, s16
    buffer_load_dwordx4 v28, s[12:15], s45 offen offset:2048 lds
    s_add_u32 s45, s45, s16
    buffer_load_dwordx4 v29, s[12:15], s45 offen offset:3072 lds
L1_q8:
    s_waitcnt lgkmcnt(1)
    v_mfma_f32_32x32x16_bf16 v[48:63], a[108:111], a[116:119], v[48:63]
    ds_read_b64_tr_b16 a[96:97], v70 offset:40960
    ds_read_b64_tr_b16 a[98:99], v70 offset:41984
    ds_read_b64_tr_b16 a[100:101], v71 offset:40960
    ds_read_b64_tr_b16 a[102:103], v71 offset:41984
    s_waitcnt lgkmcnt(2)
    v_mfma_f32_32x32x16_bf16 v[32:47], a[96:99], a[112:115], v[32:47]
    ds_read_b128 a[116:119], v75 offset:49152
    s_cbranch_vccz L1_q9
    s_add_u32 s46, s47, 36864
    s_mov_b32 m0, s46
    s_cmp_eq_u32 s20, 1
    s_cbranch_scc1 L1_q9x
    s_add_u32 s45, s45, s16
    s_add_u32 s45, s45, 4096
    buffer_load_dwordx4 v26, s[12:15], s45 offen offset:0 nt lds
    s_add_u32 s45, s45, s16
    buffer_load_dwordx4 v27, s[12:15], s45 offen offset:1024 nt lds
    s_add_u32 s45, s45, s16
    buffer_load_dwordx4 v28, s[12:15], s45 offen offset:2048 nt lds
    s_add_u32 s45, s45, s16
    buffer_load_dwordx4 v29, s[12:15], s45 offen offset:3072 nt lds
    s_branch L1_q9
L1_q9x:
    s_add_u32 s45, s45, s16
    s_add_u32 s45, s45, 4096
    buffer_load_dwordx4 v26, s[12:15], s45 offen offset:0 lds
    s_add_u32 s45, s45, s16
    buffer_load_dwordx4 v27, s[12:15], s45 offen offset:1024 lds
    s_add_u32 s45, s45, s16
    buffer_load_dwordx4 v28, s[12:15], s45 offen offset:2048 lds
    s_add_u32 s45, s45, s16
    buffer_load_dwordx4 v29, s[12:15], s45 offen offset:3072 lds
L1_q9:
    s_waitcnt lgkmcnt(1)
    v_mfma_f32_32x32x16_bf16 v[48:63], a[100:103], a[112:115], v[48:63]
    ds_read_b64_tr_b16 a[104:105], v70 offset:45056
    ds_read_b64_tr_b16 a[106:107], v70 offset:46080
    ds_read_b64_tr_b16 a[108:109], v71 offset:45056
    ds_read_b64_tr_b16 a[110:111], v71 offset:46080
    s_waitcnt lgkmcnt(0)
    s_cbranch_vccz L1_q10
    s_waitcnt vmcnt(16)
L1_q10:
    s_barrier
    v_mfma_f32_32x32x16_bf16 v[32:47], a[104:107], a[116:119], v[32:47]
    ds_read_b128 a[112:115], v66 offset:49152
    s_cbranch_vccz L1_q11
    s_add_u32 s44, s43, 4
    s_and_b32 s44, s44, 15
    s_mul_i32 s45, s44, s17
    s_add_u32 s45, s45, s24
    s_mul_i32 s47, s55, 16384
    s_add_u32 s47, s47, s23
    s_add_u32 s46, s47, 131072
    s_mov_b32 m0, s46
    s_cmp_eq_u32 s20, 1
    s_cbranch_scc1 L1_q11x
    s_nop 0
    buffer_load_dwordx4 v26, s[12:15], s45 offen offset:0 nt lds
    s_add_u32 s45, s45, s16
    buffer_load_dwordx4 v27, s[12:15], s45 offen offset:1024 nt lds
    s_add_u32 s45, s45, s16
    buffer_load_dwordx4 v28, s[12:15], s45 offen offset:2048 nt lds
    s_add_u32 s45, s45, s16
    buffer_load_dwordx4 v29, s[12:15], s45 offen offset:3072 nt lds
    s_branch L1_q11
L1_q11x:
    s_nop 0
    buffer_load_dwordx4 v26, s[12:15], s45 offen offset:0 lds
    s_add_u32 s45, s45, s16
    buffer_load_dwordx4 v27, s[12:15], s45 offen offset:1024 lds
    s_add_u32 s45, s45, s16
    buffer_load_dwordx4 v28, s[12:15], s45 offen offset:2048 lds
    s_add_u32 s45, s45, s16
    buffer_load_dwordx4 v29, s[12:15], s45 offen offset:3072 lds
L1_q11:
    v_mfma_f32_32x32x16_bf16 v[48:63], a[108:111], a[116:119], v[48:63]
    ds_read_b64_tr_b16 a[96:97], v64 offset:0
    ds_read_b64_tr_b16 a[98:99], v64 offset:1024
    ds_read_b64_tr_b16 a[100:101], v65 offset:0
    ds_read_b64_tr_b16 a[102:103], v65 offset:1024
    s_waitcnt lgkmcnt(2)
    v_mfma_f32_32x32x16_bf16 v[32:47], a[96:99], a[112:115], v[32:47]
    ds_read_b128 a[116:119], v67 offset:49152
    s_cbranch_vccz L1_q12
    s_add_u32 s46, s47, 135168
    s_mov_b32 m0, s46
    s_cmp_eq_u32 s20, 1
    s_cbranch_scc1 L1_q12x
    s_add_u32 s45, s45, s16
    s_add_u32 s45, s45, 4096
    buffer_load_dwordx4 v26, s[12:15], s45 offen offset:0 nt lds
    s_add_u32 s45, s45, s16
    buffer_load_dwordx4 v27, s[12:15], s45 offen offset:1024 nt lds
    s_add_u32 s45, s45, s16
    buffer_load_dwordx4 v28, s[12:15], s45 offen offset:2048 nt lds
    s_add_u32 s45, s45, s16
    buffer_load_dwordx4 v29, s[12:15], s45 offen offset:3072 nt lds
    s_branch L1_q12
L1_q12x:
    s_add_u32 s45, s45, s16
    s_add_u32 s45, s45, 4096
    buffer_load_dwordx4 v26, s[12:15], s45 offen offset:0 lds
    s_add_u32 s45, s45, s16
    buffer_load_dwordx4 v27, s[12:15], s45 offen offset:1024 lds
    s_add_u32 s45, s45, s16
    buffer_load_dwordx4 v28, s[12:15], s45 offen offset:2048 lds
    s_add_u32 s45, s45, s16
    buffer_load_dwordx4 v29, s[12:15], s45 offen offset:3072 lds
L1_q12:
    s_waitcnt lgkmcnt(1)
    v_mfma_f32_32x32x16_bf16 v[48:63], a[100:103], a[112:115], v[48:63]
    ds_read_b64_tr_b16 a[104:105], v64 offset:4096
    ds_read_b64_tr_b16 a[106:107], v64 offset:5120
    ds_read_b64_tr_b16 a[108:109], v65 offset:4096
    ds_read_b64_tr_b16 a[110:111], v65 offset:5120
    s_waitcnt lgkmcnt(2)
    v_mfma_f32_32x32x16_bf16 v[32:47], a[104:107], a[116:119], v[32:47]
    ds_read_b128 a[112:115], v68 offset:49152
    ds_read_b64_tr_b16 a[96:97], v64 offset:8192
    ds_read_b64_tr_b16 a[98:99], v64 offset:9216
    s_waitcnt lgkmcnt(3)
    v_mfma_f32_32x32x16_bf16 v[48:63], a[108:111], a[116:119], v[48:63]
    ds_read_b64_tr_b16 a[100:101], v65 offset:8192
    ds_read_b64_tr_b16 a[102:103], v65 offset:9216
    s_waitcnt lgkmcnt(2)
    v_mfma_f32_32x32x16_bf16 v[32:47], a[96:99], a[112:115], v[32:47]
    ds_read_b128 a[116:119], v69 offset:49152
    ds_read_b64_tr_b16 a[104:105], v64 offset:12288
    ds_read_b64_tr_b16 a[106:107], v64 offset:13312
    s_waitcnt lgkmcnt(3)
    v_mfma_f32_32x32x16_bf16 v[48:63], a[100:103], a[112:115], v[48:63]
    ds_read_b64_tr_b16 a[108:109], v65 offset:12288
    ds_read_b64_tr_b16 a[110:111], v65 offset:13312
    s_waitcnt lgkmcnt(0)
    s_cbranch_vccz L1_q13
    s_waitcnt vmcnt(16)
L1_q13:
    s_barrier
    v_mfma_f32_32x32x16_bf16 v[32:47], a[104:107], a[116:119], v[32:47]
    ds_read_b128 a[112:115], v72 offset:0
    s_cbranch_vccz L1_q14
    s_add_u32 s44, s43, 5
    s_and_b32 s44, s44, 15
    s_mul_i32 s45, s44, s17
    s_add_u32 s45, s45, s24
    s_mul_i32 s47, s55, 16384
    s_add_u32 s47, s47, s23
    s_add_u32 s46, s47, 98304
    s_mov_b32 m0, s46
    s_cmp_eq_u32 s20, 1
    s_cbranch_scc1 L1_q14x
    s_nop 0
    buffer_load_dwordx4 v26, s[12:15], s45 offen offset:0 nt lds
    s_add_u32 s45, s45, s16
    buffer_load_dwordx4 v27, s[12:15], s45 offen offset:1024 nt lds
    s_add_u32 s45, s45, s16
    buffer_load_dwordx4 v28, s[12:15], s45 offen offset:2048 nt lds
    s_add_u32 s45, s45, s16
    buffer_load_dwordx4 v29, s[12:15], s45 offen offset:3072 nt lds
    s_branch L1_q14
L1_q14x:
    s_nop 0
    buffer_load_dwordx4 v26, s[12:15], s45 offen offset:0 lds
    s_add_u32 s45, s45, s16
    buffer_load_dwordx4 v27, s[12:15], s45 offen offset:1024 lds
    s_add_u32 s45, s45, s16
    buffer_load_dwordx4 v28, s[12:15], s45 offen offset:2048 lds
    s_add_u32 s45, s45, s16
    buffer_load_dwordx4 v29, s[12:15], s45 offen offset:3072 lds
L1_q14:
    v_mfma_f32_32x32x16_bf16 v[48:63], a[108:111], a[116:119], v[48:63]
    ds_read_b64_tr_b16 a[96:97], v64 offset:16384
    ds_read_b64_tr_b16 a[98:99], v64 offset:17408
    ds_read_b64_tr_b16 a[100:101], v65 offset:16384
    ds_read_b64_tr_b16 a[102:103], v65 offset:17408
    s_waitcnt lgkmcnt(2)
    v_mfma_f32_32x32x16_bf16 v[32:47], a[96:99], a[112:115], v[32:47]
    ds_read_b128 a[116:119], v73 offset:0
    s_cbranch_vccz L1_q15
    s_add_u32 s46, s47, 102400
    s_mov_b32 m0, s46
    s_cmp_eq_u32 s20, 1
    s_cbranch_scc1 L1_q15x
    s_add_u32 s45, s45, s16
    s_add_u32 s45, s45, 4096
    buffer_load_dwordx4 v26, s[12:15], s45 offen offset:0 nt lds
    s_add_u32 s45, s45, s16
    buffer_load_dwordx4 v27, s[12:15], s45 offen offset:1024 nt lds
    s_add_u32 s45, s45, s16
    buffer_load_dwordx4 v28, s[12:15], s45 offen offset:2048 nt lds
    s_add_u32 s45, s45, s16
    buffer_load_dwordx4 v29, s[12:15], s45 offen offset:3072 nt lds
    s_branch L1_q15
L1_q15x:
    s_add_u32 s45, s45, s16
    s_add_u32 s45, s45, 4096
    buffer_load_dwordx4 v26, s[12:15], s45 offen offset:0 lds
    s_add_u32 s45, s45, s16
    buffer_load_dwordx4 v27, s[12:15], s45 offen offset:1024 lds
    s_add_u32 s45, s45, s16
    buffer_load_dwordx4 v28, s[12:15], s45 offen offset:2048 lds
    s_add_u32 s45, s45, s16
    buffer_load_dwordx4 v29, s[12:15], s45 offen offset:3072 lds
L1_q15:
    s_waitcnt lgkmcnt(1)
    v_mfma_f32_32x32x16_bf16 v[48:63], a[100:103], a[112:115], v[48:63]
    ds_read_b64_tr_b16 a[104:105], v64 offset:20480
    ds_read_b64_tr_b16 a[106:107], v64 offset:21504
    ds_read_b64_tr_b16 a[108:109], v65 offset:20480
    ds_read_b64_tr_b16 a[110:111], v65 offset:21504
    s_waitcnt lgkmcnt(2)
    v_mfma_f32_32x32x16_bf16 v[32:47], a[104:107], a[116:119], v[32:47]
    ds_read_b128 a[112:115], v74 offset:0
    ds_read_b64_tr_b16 a[96:97], v64 offset:24576
    ds_read_b64_tr_b16 a[98:99], v64 offset:25600
    s_waitcnt lgkmcnt(3)
    v_mfma_f32_32x32x16_bf16 v[48:63], a[108:111], a[116:119], v[48:63]
    ds_read_b64_tr_b16 a[100:101], v65 offset:24576
    ds_read_b64_tr_b16 a[102:103], v65 offset:25600
    s_waitcnt lgkmcnt(2)
    v_mfma_f32_32x32x16_bf16 v[32:47], a[96:99], a[112:115], v[32:47]
    ds_read_b128 a[116:119], v75 offset:0
    ds_read_b64_tr_b16 a[104:105], v64 offset:28672
    ds_read_b64_tr_b16 a[106:107], v64 offset:29696
    s_waitcnt lgkmcnt(3)
    v_mfma_f32_32x32x16_bf16 v[48:63], a[100:103], a[112:115], v[48:63]
    ds_read_b64_tr_b16 a[108:109], v65 offset:28672
    ds_read_b64_tr_b16 a[110:111], v65 offset:29696
    s_waitcnt lgkmcnt(0)
    s_cbranch_vccz L1_q16
    s_waitcnt vmcnt(16)
L1_q16:
    s_barrier
    v_mfma_f32_32x32x16_bf16 v[32:47], a[104:107], a[116:119], v[32:47]
    ds_read_b128 a[112:115], v72 offset:16384
    s_cbranch_vccz L1_q17
    s_add_u32 s44, s43, 6
    s_and_b32 s44, s44, 15
    s_mul_i32 s45, s44, s17
    s_add_u32 s45, s45, s24
    s_mul_i32 s47, s55, 49152
    s_add_u32 s47, s47, s23
    s_add_u32 s46, s47, 0
    s_mov_b32 m0, s46
    s_cmp_eq_u32 s20, 1
    s_cbranch_scc1 L1_q17x
    s_nop 0
    buffer_load_dwordx4 v26, s[12:15], s45 offen offset:0 nt lds
    s_add_u32 s45, s45, s16
    buffer_load_dwordx4 v27, s[12:15], s45 offen offset:1024 nt lds
    s_add_u32 s45, s45, s16
    buffer_load_dwordx4 v28, s[12:15], s45 offen offset:2048 nt lds
    s_add_u32 s45, s45, s16
    buffer_load_dwordx4 v29, s[12:15], s45 offen offset:3072 nt lds
    s_branch L1_q17
L1_q17x:
    s_nop 0
    buffer_load_dwordx4 v26, s[12:15], s45 offen offset:0 lds
    s_add_u32 s45, s45, s16
    buffer_load_dwordx4 v27, s[12:15], s45 offen offset:1024 lds
    s_add_u32 s45, s45, s16
    buffer_load_dwordx4 v28, s[12:15], s45 offen offset:2048 lds
    s_add_u32 s45, s45, s16
    buffer_load_dwordx4 v29, s[12:15], s45 offen offset:3072 lds
L1_q17:
    v_mfma_f32_32x32x16_bf16 v[48:63], a[108:111], a[116:119], v[48:63]
    ds_read_b64_tr_b16 a[96:97], v64 offset:32768
    ds_read_b64_tr_b16 a[98:99], v64 offset:33792
    ds_read_b64_tr_b16 a[100:101], v65 offset:32768
    ds_read_b64_tr_b16 a[102:103], v65 offset:33792
    s_waitcnt lgkmcnt(2)
    v_mfma_f32_32x32x16_bf16 v[32:47], a[96:99], a[112:115], v[32:47]
    ds_read_b128 a[116:119], v73 offset:16384
    s_cbranch_vccz L1_q18
    s_add_u32 s46, s47, 4096
    s_mov_b32 m0, s46
    s_cmp_eq_u32 s20, 1
    s_cbranch_scc1 L1_q18x
    s_add_u32 s45, s45, s16
    s_add_u32 s45, s45, 4096
    buffer_load_dwordx4 v26, s[12:15], s45 offen offset:0 nt lds
    s_add_u32 s45, s45, s16
    buffer_load_dwordx4 v27, s[12:15], s45 offen offset:1024 nt lds
    s_add_u32 s45, s45, s16
    buffer_load_dwordx4 v28, s[12:15], s45 offen offset:2048 nt lds
    s_add_u32 s45, s45, s16
    buffer_load_dwordx4 v29, s[12:15], s45 offen offset:3072 nt lds
    s_branch L1_q18
L1_q18x:
    s_add_u32 s45, s45, s16
    s_add_u32 s45, s45, 4096
    buffer_load_dwordx4 v26, s[12:15], s45 offen offset:0 lds
    s_add_u32 s45, s45, s16
    buffer_load_dwordx4 v27, s[12:15], s45 offen offset:1024 lds
    s_add_u32 s45, s45, s16
    buffer_load_dwordx4 v28, s[12:15], s45 offen offset:2048 lds
    s_add_u32 s45, s45, s16
    buffer_load_dwordx4 v29, s[12:15], s45 offen offset:3072 lds
L1_q18:
    s_waitcnt lgkmcnt(1)
    v_mfma_f32_32x32x16_bf16 v[48:63], a[100:103], a[112:115], v[48:63]
    ds_read_b64_tr_b16 a[104:105], v64 offset:36864
    ds_read_b64_tr_b16 a[106:107], v64 offset:37888
    ds_read_b64_tr_b16 a[108:109], v65 offset:36864
    ds_read_b64_tr_b16 a[110:111], v65 offset:37888
    s_waitcnt lgkmcnt(2)
    v_mfma_f32_32x32x16_bf16 v[32:47], a[104:107], a[116:119], v[32:47]
    ds_read_b128 a[112:115], v74 offset:16384
    ds_read_b64_tr_b16 a[96:97], v64 offset:40960
    ds_read_b64_tr_b16 a[98:99], v64 offset:41984
    s_waitcnt lgkmcnt(3)
    v_mfma_f32_32x32x16_bf16 v[48:63], a[108:111], a[116:119], v[48:63]
    ds_read_b64_tr_b16 a[100:101], v65 offset:40960
    ds_read_b64_tr_b16 a[102:103], v65 offset:41984
    s_waitcnt lgkmcnt(2)
    v_mfma_f32_32x32x16_bf16 v[32:47], a[96:99], a[112:115], v[32:47]
    ds_read_b128 a[116:119], v75 offset:16384
    ds_read_b64_tr_b16 a[104:105], v64 offset:45056
    ds_read_b64_tr_b16 a[106:107], v64 offset:46080
    s_waitcnt lgkmcnt(3)
    v_mfma_f32_32x32x16_bf16 v[48:63], a[100:103], a[112:115], v[48:63]
    ds_read_b64_tr_b16 a[108:109], v65 offset:45056
    ds_read_b64_tr_b16 a[110:111], v65 offset:46080
    s_waitcnt lgkmcnt(0)
    s_cbranch_vccz L1_q19
    s_waitcnt vmcnt(16)
L1_q19:
    s_barrier
    v_mfma_f32_32x32x16_bf16 v[32:47], a[104:107], a[116:119], v[32:47]
    ds_read_b128 a[112:115], v78 offset:16384
    s_cbranch_vccz L1_q20
    s_add_u32 s44, s43, 7
    s_and_b32 s44, s44, 15
    s_mul_i32 s45, s44, s17
    s_add_u32 s45, s45, s24
    s_mul_i32 s47, s55, 49152
    s_add_u32 s47, s47, s23
    s_add_u32 s46, s47, 16384
    s_mov_b32 m0, s46
    s_cmp_eq_u32 s20, 1
    s_cbranch_scc1 L1_q20x
    s_nop 0
    buffer_load_dwordx4 v26, s[12:15], s45 offen offset:0 nt lds
    s_add_u32 s45, s45, s16
    buffer_load_dwordx4 v27, s[12:15], s45 offen offset:1024 nt lds
    s_add_u32 s45, s45, s16
    buffer_load_dwordx4 v28, s[12:15], s45 offen offset:2048 nt lds
    s_add_u32 s45, s45, s16
    buffer_load_dwordx4 v29, s[12:15], s45 offen offset:3072 nt lds
    s_branch L1_q20
L1_q20x:
    s_nop 0
    buffer_load_dwordx4 v26, s[12:15], s45 offen offset:0 lds
    s_add_u32 s45, s45, s16
    buffer_load_dwordx4 v27, s[12:15], s45 offen offset:1024 lds
    s_add_u32 s45, s45, s16
    buffer_load_dwordx4 v28, s[12:15], s45 offen offset:2048 lds
    s_add_u32 s45, s45, s16
    buffer_load_dwordx4 v29, s[12:15], s45 offen offset:3072 lds
L1_q20:
    v_mfma_f32_32x32x16_bf16 v[48:63], a[108:111], a[116:119], v[48:63]
    ds_read_b64_tr_b16 a[96:97], v76 offset:0
    ds_read_b64_tr_b16 a[98:99], v76 offset:1024
    ds_read_b64_tr_b16 a[100:101], v77 offset:0
    ds_read_b64_tr_b16 a[102:103], v77 offset:1024
    s_waitcnt lgkmcnt(2)
    v_mfma_f32_32x32x16_bf16 v[32:47], a[96:99], a[112:115], v[32:47]
    ds_read_b128 a[116:119], v79 offset:16384
    s_cbranch_vccz L1_q21
    s_add_u32 s46, s47, 20480
    s_mov_b32 m0, s46
    s_cmp_eq_u32 s20, 1
    s_cbranch_scc1 L1_q21x
    s_add_u32 s45, s45, s16
    s_add_u32 s45, s45, 4096
    buffer_load_dwordx4 v26, s[12:15], s45 offen offset:0 nt lds
    s_add_u32 s45, s45, s16
    buffer_load_dwordx4 v27, s[12:15], s45 offen offset:1024 nt lds
    s_add_u32 s45, s45, s16
    buffer_load_dwordx4 v28, s[12:15], s45 offen offset:2048 nt lds
    s_add_u32 s45, s45, s16
    buffer_load_dwordx4 v29, s[12:15], s45 offen offset:3072 nt lds
    s_branch L1_q21
L1_q21x:
    s_add_u32 s45, s45, s16
    s_add_u32 s45, s45, 4096
    buffer_load_dwordx4 v26, s[12:15], s45 offen offset:0 lds
    s_add_u32 s45, s45, s16
    buffer_load_dwordx4 v27, s[12:15], s45 offen offset:1024 lds
    s_add_u32 s45, s45, s16
    buffer_load_dwordx4 v28, s[12:15], s45 offen offset:2048 lds
    s_add_u32 s45, s45, s16
    buffer_load_dwordx4 v29, s[12:15], s45 offen offset:3072 lds
L1_q21:
    s_waitcnt lgkmcnt(1)
    v_mfma_f32_32x32x16_bf16 v[48:63], a[100:103], a[112:115], v[48:63]
    ds_read_b64_tr_b16 a[104:105], v76 offset:4096
    ds_read_b64_tr_b16 a[106:107], v76 offset:5120
    ds_read_b64_tr_b16 a[108:109], v77 offset:4096
    ds_read_b64_tr_b16 a[110:111], v77 offset:5120
    s_waitcnt lgkmcnt(2)
    v_mfma_f32_32x32x16_bf16 v[32:47], a[104:107], a[116:119], v[32:47]
    ds_read_b128 a[112:115], v80 offset:16384
    ds_read_b64_tr_b16 a[96:97], v76 offset:8192
    ds_read_b64_tr_b16 a[98:99], v76 offset:9216
    s_waitcnt lgkmcnt(3)
    v_mfma_f32_32x32x16_bf16 v[48:63], a[108:111], a[116:119], v[48:63]
    ds_read_b64_tr_b16 a[100:101], v77 offset:8192
    ds_read_b64_tr_b16 a[102:103], v77 offset:9216
    s_waitcnt lgkmcnt(2)
    v_mfma_f32_32x32x16_bf16 v[32:47], a[96:99], a[112:115], v[32:47]
    ds_read_b128 a[116:119], v81 offset:16384
    ds_read_b64_tr_b16 a[104:105], v76 offset:12288
    ds_read_b64_tr_b16 a[106:107], v76 offset:13312
    s_waitcnt lgkmcnt(3)
    v_mfma_f32_32x32x16_bf16 v[48:63], a[100:103], a[112:115], v[48:63]
    ds_read_b64_tr_b16 a[108:109], v77 offset:12288
    ds_read_b64_tr_b16 a[110:111], v77 offset:13312
    s_waitcnt lgkmcnt(0)
    s_cbranch_vccz L1_q22
    s_waitcnt vmcnt(16)
L1_q22:
    s_barrier
    v_mfma_f32_32x32x16_bf16 v[32:47], a[104:107], a[116:119], v[32:47]
    ds_read_b128 a[112:115], v72 offset:49152
    s_cbranch_vccz L1_q23
    s_add_u32 s44, s43, 8
    s_and_b32 s44, s44, 15
    s_mul_i32 s45, s44, s17
    s_add_u32 s45, s45, s24
    s_mul_i32 s47, s55, 49152
    s_add_u32 s47, s47, s23
    s_add_u32 s46, s47, 32768
    s_mov_b32 m0, s46
    s_cmp_eq_u32 s20, 1
    s_cbranch_scc1 L1_q23x
    s_nop 0
    buffer_load_dwordx4 v26, s[12:15], s45 offen offset:0 nt lds
    s_add_u32 s45, s45, s16
    buffer_load_dwordx4 v27, s[12:15], s45 offen offset:1024 nt lds
    s_add_u32 s45, s45, s16
    buffer_load_dwordx4 v28, s[12:15], s45 offen offset:2048 nt lds
    s_add_u32 s45, s45, s16
    buffer_load_dwordx4 v29, s[12:15], s45 offen offset:3072 nt lds
    s_branch L1_q23
L1_q23x:
    s_nop 0
    buffer_load_dwordx4 v26, s[12:15], s45 offen offset:0 lds
    s_add_u32 s45, s45, s16
    buffer_load_dwordx4 v27, s[12:15], s45 offen offset:1024 lds
    s_add_u32 s45, s45, s16
    buffer_load_dwordx4 v28, s[12:15], s45 offen offset:2048 lds
    s_add_u32 s45, s45, s16
    buffer_load_dwordx4 v29, s[12:15], s45 offen offset:3072 lds
L1_q23:
    v_mfma_f32_32x32x16_bf16 v[48:63], a[108:111], a[116:119], v[48:63]
    ds_read_b64_tr_b16 a[96:97], v70 offset:32768
    ds_read_b64_tr_b16 a[98:99], v70 offset:33792
    ds_read_b64_tr_b16 a[100:101], v71 offset:32768
    ds_read_b64_tr_b16 a[102:103], v71 offset:33792
    s_waitcnt lgkmcnt(2)
    v_mfma_f32_32x32x16_bf16 v[32:47], a[96:99], a[112:115], v[32:47]
    ds_read_b128 a[116:119], v73 offset:49152
    s_cbranch_vccz L1_q24
    s_add_u32 s46, s47, 36864
    s_mov_b32 m0, s46
    s_cmp_eq_u32 s20, 1
    s_cbranch_scc1 L1_q24x
    s_add_u32 s45, s45, s16
    s_add_u32 s45, s45, 4096
    buffer_load_dwordx4 v26, s[12:15], s45 offen offset:0 nt lds
    s_add_u32 s45, s45, s16
    buffer_load_dwordx4 v27, s[12:15], s45 offen offset:1024 nt lds
    s_add_u32 s45, s45, s16
    buffer_load_dwordx4 v28, s[12:15], s45 offen offset:2048 nt lds
    s_add_u32 s45, s45, s16
    buffer_load_dwordx4 v29, s[12:15], s45 offen offset:3072 nt lds
    s_branch L1_q24
L1_q24x:
    s_add_u32 s45, s45, s16
    s_add_u32 s45, s45, 4096
    buffer_load_dwordx4 v26, s[12:15], s45 offen offset:0 lds
    s_add_u32 s45, s45, s16
    buffer_load_dwordx4 v27, s[12:15], s45 offen offset:1024 lds
    s_add_u32 s45, s45, s16
    buffer_load_dwordx4 v28, s[12:15], s45 offen offset:2048 lds
    s_add_u32 s45, s45, s16
    buffer_load_dwordx4 v29, s[12:15], s45 offen offset:3072 lds
L1_q24:
    s_waitcnt lgkmcnt(1)
    v_mfma_f32_32x32x16_bf16 v[48:63], a[100:103], a[112:115], v[48:63]
    ds_read_b64_tr_b16 a[104:105], v70 offset:36864
    ds_read_b64_tr_b16 a[106:107], v70 offset:37888
    ds_read_b64_tr_b16 a[108:109], v71 offset:36864
    ds_read_b64_tr_b16 a[110:111], v71 offset:37888
    s_waitcnt lgkmcnt(2)
    v_mfma_f32_32x32x16_bf16 v[32:47], a[104:107], a[116:119], v[32:47]
    ds_read_b128 a[112:115], v74 offset:49152
    ds_read_b64_tr_b16 a[96:97], v70 offset:40960
    ds_read_b64_tr_b16 a[98:99], v70 offset:41984
    s_waitcnt lgkmcnt(3)
    v_mfma_f32_32x32x16_bf16 v[48:63], a[108:111], a[116:119], v[48:63]
    ds_read_b64_tr_b16 a[100:101], v71 offset:40960
    ds_read_b64_tr_b16 a[102:103], v71 offset:41984
    s_waitcnt lgkmcnt(2)
    v_mfma_f32_32x32x16_bf16 v[32:47], a[96:99], a[112:115], v[32:47]
    ds_read_b128 a[116:119], v75 offset:49152
    ds_read_b64_tr_b16 a[104:105], v70 offset:45056
    ds_read_b64_tr_b16 a[106:107], v70 offset:46080
    s_waitcnt lgkmcnt(3)
    v_mfma_f32_32x32x16_bf16 v[48:63], a[100:103], a[112:115], v[48:63]
    ds_read_b64_tr_b16 a[108:109], v71 offset:45056
    ds_read_b64_tr_b16 a[110:111], v71 offset:46080
    s_waitcnt lgkmcnt(0)
    s_cbranch_vccz L1_q25
    s_waitcnt vmcnt(16)
L1_q25:
    s_barrier
    v_mfma_f32_32x32x16_bf16 v[32:47], a[104:107], a[116:119], v[32:47]
    ds_read_b128 a[112:115], v66 offset:49152
    s_cbranch_vccz L1_q26
    s_add_u32 s44, s43, 9
    s_and_b32 s44, s44, 15
    s_mul_i32 s45, s44, s17
    s_add_u32 s45, s45, s24
    s_mul_i32 s47, s55, 16384
    s_add_u32 s47, s47, s23
    s_add_u32 s46, s47, 131072
    s_mov_b32 m0, s46
    s_cmp_eq_u32 s20, 1
    s_cbranch_scc1 L1_q26x
    s_nop 0
    buffer_load_dwordx4 v26, s[12:15], s45 offen offset:0 nt lds
    s_add_u32 s45, s45, s16
    buffer_load_dwordx4 v27, s[12:15], s45 offen offset:1024 nt lds
    s_add_u32 s45, s45, s16
    buffer_load_dwordx4 v28, s[12:15], s45 offen offset:2048 nt lds
    s_add_u32 s45, s45, s16
    buffer_load_dwordx4 v29, s[12:15], s45 offen offset:3072 nt lds
    s_branch L1_q26
L1_q26x:
    s_nop 0
    buffer_load_dwordx4 v26, s[12:15], s45 offen offset:0 lds
    s_add_u32 s45, s45, s16
    buffer_load_dwordx4 v27, s[12:15], s45 offen offset:1024 lds
    s_add_u32 s45, s45, s16
    buffer_load_dwordx4 v28, s[12:15], s45 offen offset:2048 lds
    s_add_u32 s45, s45, s16
    buffer_load_dwordx4 v29, s[12:15], s45 offen offset:3072 lds
L1_q26:
    v_mfma_f32_32x32x16_bf16 v[48:63], a[108:111], a[116:119], v[48:63]
    ds_read_b64_tr_b16 a[96:97], v64 offset:0
    ds_read_b64_tr_b16 a[98:99], v64 offset:1024
    ds_read_b64_tr_b16 a[100:101], v65 offset:0
    ds_read_b64_tr_b16 a[102:103], v65 offset:1024
    s_waitcnt lgkmcnt(2)
    v_mfma_f32_32x32x16_bf16 v[32:47], a[96:99], a[112:115], v[32:47]
    ds_read_b128 a[116:119], v67 offset:49152
    s_cbranch_vccz L1_q27
    s_add_u32 s46, s47, 135168
    s_mov_b32 m0, s46
    s_cmp_eq_u32 s20, 1
    s_cbranch_scc1 L1_q27x
    s_add_u32 s45, s45, s16
    s_add_u32 s45, s45, 4096
    buffer_load_dwordx4 v26, s[12:15], s45 offen offset:0 nt lds
    s_add_u32 s45, s45, s16
    buffer_load_dwordx4 v27, s[12:15], s45 offen offset:1024 nt lds
    s_add_u32 s45, s45, s16
    buffer_load_dwordx4 v28, s[12:15], s45 offen offset:2048 nt lds
    s_add_u32 s45, s45, s16
    buffer_load_dwordx4 v29, s[12:15], s45 offen offset:3072 nt lds
    s_branch L1_q27
L1_q27x:
    s_add_u32 s45, s45, s16
    s_add_u32 s45, s45, 4096
    buffer_load_dwordx4 v26, s[12:15], s45 offen offset:0 lds
    s_add_u32 s45, s45, s16
    buffer_load_dwordx4 v27, s[12:15], s45 offen offset:1024 lds
    s_add_u32 s45, s45, s16
    buffer_load_dwordx4 v28, s[12:15], s45 offen offset:2048 lds
    s_add_u32 s45, s45, s16
    buffer_load_dwordx4 v29, s[12:15], s45 offen offset:3072 lds
L1_q27:
    s_waitcnt lgkmcnt(1)
    v_mfma_f32_32x32x16_bf16 v[48:63], a[100:103], a[112:115], v[48:63]
    ds_read_b64_tr_b16 a[104:105], v64 offset:4096
    ds_read_b64_tr_b16 a[106:107], v64 offset:5120
    ds_read_b64_tr_b16 a[108:109], v65 offset:4096
    ds_read_b64_tr_b16 a[110:111], v65 offset:5120
    s_waitcnt lgkmcnt(2)
    v_mfma_f32_32x32x16_bf16 v[32:47], a[104:107], a[116:119], v[32:47]
    ds_read_b128 a[112:115], v68 offset:49152
    ds_read_b64_tr_b16 a[96:97], v64 offset:8192
    ds_read_b64_tr_b16 a[98:99], v64 offset:9216
    s_waitcnt lgkmcnt(3)
    v_mfma_f32_32x32x16_bf16 v[48:63], a[108:111], a[116:119], v[48:63]
    ds_read_b64_tr_b16 a[100:101], v65 offset:8192
    ds_read_b64_tr_b16 a[102:103], v65 offset:9216
    s_waitcnt lgkmcnt(2)
    v_mfma_f32_32x32x16_bf16 v[32:47], a[96:99], a[112:115], v[32:47]
    ds_read_b128 a[116:119], v69 offset:49152
    ds_read_b64_tr_b16 a[104:105], v64 offset:12288
    ds_read_b64_tr_b16 a[106:107], v64 offset:13312
    s_waitcnt lgkmcnt(3)
    v_mfma_f32_32x32x16_bf16 v[48:63], a[100:103], a[112:115], v[48:63]
    ds_read_b64_tr_b16 a[108:109], v65 offset:12288
    ds_read_b64_tr_b16 a[110:111], v65 offset:13312
    s_waitcnt lgkmcnt(0)
    s_cbranch_vccz L1_q28
    s_waitcnt vmcnt(16)
L1_q28:
    s_barrier
    v_mfma_f32_32x32x16_bf16 v[32:47], a[104:107], a[116:119], v[32:47]
    ds_read_b128 a[112:115], v72 offset:0
    s_cbranch_vccz L1_q29
    s_add_u32 s44, s43, 10
    s_and_b32 s44, s44, 15
    s_mul_i32 s45, s44, s17
    s_add_u32 s45, s45, s24
    s_mul_i32 s47, s55, 16384
    s_add_u32 s47, s47, s23
    s_add_u32 s46, s47, 98304
    s_mov_b32 m0, s46
    s_cmp_eq_u32 s20, 1
    s_cbranch_scc1 L1_q29x
    s_nop 0
    buffer_load_dwordx4 v26, s[12:15], s45 offen offset:0 nt lds
    s_add_u32 s45, s45, s16
    buffer_load_dwordx4 v27, s[12:15], s45 offen offset:1024 nt lds
    s_add_u32 s45, s45, s16
    buffer_load_dwordx4 v28, s[12:15], s45 offen offset:2048 nt lds
    s_add_u32 s45, s45, s16
    buffer_load_dwordx4 v29, s[12:15], s45 offen offset:3072 nt lds
    s_branch L1_q29
L1_q29x:
    s_nop 0
    buffer_load_dwordx4 v26, s[12:15], s45 offen offset:0 lds
    s_add_u32 s45, s45, s16
    buffer_load_dwordx4 v27, s[12:15], s45 offen offset:1024 lds
    s_add_u32 s45, s45, s16
    buffer_load_dwordx4 v28, s[12:15], s45 offen offset:2048 lds
    s_add_u32 s45, s45, s16
    buffer_load_dwordx4 v29, s[12:15], s45 offen offset:3072 lds
L1_q29:
    v_mfma_f32_32x32x16_bf16 v[48:63], a[108:111], a[116:119], v[48:63]
    ds_read_b64_tr_b16 a[96:97], v64 offset:16384
    ds_read_b64_tr_b16 a[98:99], v64 offset:17408
    ds_read_b64_tr_b16 a[100:101], v65 offset:16384
    ds_read_b64_tr_b16 a[102:103], v65 offset:17408
    s_waitcnt lgkmcnt(2)
    v_mfma_f32_32x32x16_bf16 v[32:47], a[96:99], a[112:115], v[32:47]
    ds_read_b128 a[116:119], v73 offset:0
    s_cbranch_vccz L1_q30
    s_add_u32 s46, s47, 102400
    s_mov_b32 m0, s46
    s_cmp_eq_u32 s20, 1
    s_cbranch_scc1 L1_q30x
    s_add_u32 s45, s45, s16
    s_add_u32 s45, s45, 4096
    buffer_load_dwordx4 v26, s[12:15], s45 offen offset:0 nt lds
    s_add_u32 s45, s45, s16
    buffer_load_dwordx4 v27, s[12:15], s45 offen offset:1024 nt lds
    s_add_u32 s45, s45, s16
    buffer_load_dwordx4 v28, s[12:15], s45 offen offset:2048 nt lds
    s_add_u32 s45, s45, s16
    buffer_load_dwordx4 v29, s[12:15], s45 offen offset:3072 nt lds
    s_branch L1_q30
L1_q30x:
    s_add_u32 s45, s45, s16
    s_add_u32 s45, s45, 4096
    buffer_load_dwordx4 v26, s[12:15], s45 offen offset:0 lds
    s_add_u32 s45, s45, s16
    buffer_load_dwordx4 v27, s[12:15], s45 offen offset:1024 lds
    s_add_u32 s45, s45, s16
    buffer_load_dwordx4 v28, s[12:15], s45 offen offset:2048 lds
    s_add_u32 s45, s45, s16
    buffer_load_dwordx4 v29, s[12:15], s45 offen offset:3072 lds
L1_q30:
    s_waitcnt lgkmcnt(1)
    v_mfma_f32_32x32x16_bf16 v[48:63], a[100:103], a[112:115], v[48:63]
    ds_read_b64_tr_b16 a[104:105], v64 offset:20480
    ds_read_b64_tr_b16 a[106:107], v64 offset:21504
    ds_read_b64_tr_b16 a[108:109], v65 offset:20480
    ds_read_b64_tr_b16 a[110:111], v65 offset:21504
    s_waitcnt lgkmcnt(2)
    v_mfma_f32_32x32x16_bf16 v[32:47], a[104:107], a[116:119], v[32:47]
    ds_read_b128 a[112:115], v74 offset:0
    ds_read_b64_tr_b16 a[96:97], v64 offset:24576
    ds_read_b64_tr_b16 a[98:99], v64 offset:25600
    s_waitcnt lgkmcnt(3)
    v_mfma_f32_32x32x16_bf16 v[48:63], a[108:111], a[116:119], v[48:63]
    ds_read_b64_tr_b16 a[100:101], v65 offset:24576
    ds_read_b64_tr_b16 a[102:103], v65 offset:25600
    s_waitcnt lgkmcnt(2)
    v_mfma_f32_32x32x16_bf16 v[32:47], a[96:99], a[112:115], v[32:47]
    ds_read_b128 a[116:119], v75 offset:0
    ds_read_b64_tr_b16 a[104:105], v64 offset:28672
    ds_read_b64_tr_b16 a[106:107], v64 offset:29696
    s_waitcnt lgkmcnt(3)
    v_mfma_f32_32x32x16_bf16 v[48:63], a[100:103], a[112:115], v[48:63]
    ds_read_b64_tr_b16 a[108:109], v65 offset:28672
    ds_read_b64_tr_b16 a[110:111], v65 offset:29696
    s_waitcnt lgkmcnt(0)
    s_cbranch_vccz L1_q31
    s_waitcnt vmcnt(16)
L1_q31:
    s_barrier
    v_mfma_f32_32x32x16_bf16 v[32:47], a[104:107], a[116:119], v[32:47]
    ds_read_b128 a[112:115], v72 offset:16384
    s_cbranch_vccz L1_q32
    s_add_u32 s44, s43, 11
    s_and_b32 s44, s44, 15
    s_mul_i32 s45, s44, s17
    s_add_u32 s45, s45, s24
    s_mul_i32 s47, s55, 49152
    s_add_u32 s47, s47, s23
    s_add_u32 s46, s47, 0
    s_mov_b32 m0, s46
    s_cmp_eq_u32 s20, 1
    s_cbranch_scc1 L1_q32x
    s_nop 0
    buffer_load_dwordx4 v26, s[12:15], s45 offen offset:0 nt lds
    s_add_u32 s45, s45, s16
    buffer_load_dwordx4 v27, s[12:15], s45 offen offset:1024 nt lds
    s_add_u32 s45, s45, s16
    buffer_load_dwordx4 v28, s[12:15], s45 offen offset:2048 nt lds
    s_add_u32 s45, s45, s16
    buffer_load_dwordx4 v29, s[12:15], s45 offen offset:3072 nt lds
    s_branch L1_q32
L1_q32x:
    s_nop 0
    buffer_load_dwordx4 v26, s[12:15], s45 offen offset:0 lds
    s_add_u32 s45, s45, s16
    buffer_load_dwordx4 v27, s[12:15], s45 offen offset:1024 lds
    s_add_u32 s45, s45, s16
    buffer_load_dwordx4 v28, s[12:15], s45 offen offset:2048 lds
    s_add_u32 s45, s45, s16
    buffer_load_dwordx4 v29, s[12:15], s45 offen offset:3072 lds
L1_q32:
    v_mfma_f32_32x32x16_bf16 v[48:63], a[108:111], a[116:119], v[48:63]
    ds_read_b64_tr_b16 a[96:97], v64 offset:32768
    ds_read_b64_tr_b16 a[98:99], v64 offset:33792
    ds_read_b64_tr_b16 a[100:101], v65 offset:32768
    ds_read_b64_tr_b16 a[102:103], v65 offset:33792
    s_waitcnt lgkmcnt(2)
    v_mfma_f32_32x32x16_bf16 v[32:47], a[96:99], a[112:115], v[32:47]
    ds_read_b128 a[116:119], v73 offset:16384
    s_cbranch_vccz L1_q33
    s_add_u32 s46, s47, 4096
    s_mov_b32 m0, s46
    s_cmp_eq_u32 s20, 1
    s_cbranch_scc1 L1_q33x
    s_add_u32 s45, s45, s16
    s_add_u32 s45, s45, 4096
    buffer_load_dwordx4 v26, s[12:15], s45 offen offset:0 nt lds
    s_add_u32 s45, s45, s16
    buffer_load_dwordx4 v27, s[12:15], s45 offen offset:1024 nt lds
    s_add_u32 s45, s45, s16
    buffer_load_dwordx4 v28, s[12:15], s45 offen offset:2048 nt lds
    s_add_u32 s45, s45, s16
    buffer_load_dwordx4 v29, s[12:15], s45 offen offset:3072 nt lds
    s_branch L1_q33
L1_q33x:
    s_add_u32 s45, s45, s16
    s_add_u32 s45, s45, 4096
    buffer_load_dwordx4 v26, s[12:15], s45 offen offset:0 lds
    s_add_u32 s45, s45, s16
    buffer_load_dwordx4 v27, s[12:15], s45 offen offset:1024 lds
    s_add_u32 s45, s45, s16
    buffer_load_dwordx4 v28, s[12:15], s45 offen offset:2048 lds
    s_add_u32 s45, s45, s16
    buffer_load_dwordx4 v29, s[12:15], s45 offen offset:3072 lds
L1_q33:
    s_waitcnt lgkmcnt(1)
    v_mfma_f32_32x32x16_bf16 v[48:63], a[100:103], a[112:115], v[48:63]
    ds_read_b64_tr_b16 a[104:105], v64 offset:36864
    ds_read_b64_tr_b16 a[106:107], v64 offset:37888
    ds_read_b64_tr_b16 a[108:109], v65 offset:36864
    ds_read_b64_tr_b16 a[110:111], v65 offset:37888
    s_waitcnt lgkmcnt(2)
    v_mfma_f32_32x32x16_bf16 v[32:47], a[104:107], a[116:119], v[32:47]
    ds_read_b128 a[112:115], v74 offset:16384
    ds_read_b64_tr_b16 a[96:97], v64 offset:40960
    ds_read_b64_tr_b16 a[98:99], v64 offset:41984
    s_waitcnt lgkmcnt(3)
    v_mfma_f32_32x32x16_bf16 v[48:63], a[108:111], a[116:119], v[48:63]
    ds_read_b64_tr_b16 a[100:101], v65 offset:40960
    ds_read_b64_tr_b16 a[102:103], v65 offset:41984
    s_waitcnt lgkmcnt(2)
    v_mfma_f32_32x32x16_bf16 v[32:47], a[96:99], a[112:115], v[32:47]
    ds_read_b128 a[116:119], v75 offset:16384
    ds_read_b64_tr_b16 a[104:105], v64 offset:45056
    ds_read_b64_tr_b16 a[106:107], v64 offset:46080
    s_waitcnt lgkmcnt(3)
    v_mfma_f32_32x32x16_bf16 v[48:63], a[100:103], a[112:115], v[48:63]
    ds_read_b64_tr_b16 a[108:109], v65 offset:45056
    ds_read_b64_tr_b16 a[110:111], v65 offset:46080
    s_waitcnt lgkmcnt(0)
    s_cbranch_vccz L1_q34
    s_waitcnt vmcnt(16)
L1_q34:
    s_barrier
    v_mfma_f32_32x32x16_bf16 v[32:47], a[104:107], a[116:119], v[32:47]
    ds_read_b128 a[112:115], v78 offset:16384
    s_cbranch_vccz L1_q35
    s_add_u32 s44, s43, 12
    s_and_b32 s44, s44, 15
    s_mul_i32 s45, s44, s17
    s_add_u32 s45, s45, s24
    s_mul_i32 s47, s55, 49152
    s_add_u32 s47, s47, s23
    s_add_u32 s46, s47, 16384
    s_mov_b32 m0, s46
    s_cmp_eq_u32 s20, 1
    s_cbranch_scc1 L1_q35x
    s_nop 0
    buffer_load_dwordx4 v26, s[12:15], s45 offen offset:0 nt lds
    s_add_u32 s45, s45, s16
    buffer_load_dwordx4 v27, s[12:15], s45 offen offset:1024 nt lds
    s_add_u32 s45, s45, s16
    buffer_load_dwordx4 v28, s[12:15], s45 offen offset:2048 nt lds
    s_add_u32 s45, s45, s16
    buffer_load_dwordx4 v29, s[12:15], s45 offen offset:3072 nt lds
    s_branch L1_q35
L1_q35x:
    s_nop 0
    buffer_load_dwordx4 v26, s[12:15], s45 offen offset:0 lds
    s_add_u32 s45, s45, s16
    buffer_load_dwordx4 v27, s[12:15], s45 offen offset:1024 lds
    s_add_u32 s45, s45, s16
    buffer_load_dwordx4 v28, s[12:15], s45 offen offset:2048 lds
    s_add_u32 s45, s45, s16
    buffer_load_dwordx4 v29, s[12:15], s45 offen offset:3072 lds
L1_q35:
    v_mfma_f32_32x32x16_bf16 v[48:63], a[108:111], a[116:119], v[48:63]
    ds_read_b64_tr_b16 a[96:97], v76 offset:0
    ds_read_b64_tr_b16 a[98:99], v76 offset:1024
    ds_read_b64_tr_b16 a[100:101], v77 offset:0
    ds_read_b64_tr_b16 a[102:103], v77 offset:1024
    s_waitcnt lgkmcnt(2)
    v_mfma_f32_32x32x16_bf16 v[32:47], a[96:99], a[112:115], v[32:47]
    ds_read_b128 a[116:119], v79 offset:16384
    s_cbranch_vccz L1_q36
    s_add_u32 s46, s47, 20480
    s_mov_b32 m0, s46
    s_cmp_eq_u32 s20, 1
    s_cbranch_scc1 L1_q36x
    s_add_u32 s45, s45, s16
    s_add_u32 s45, s45, 4096
    buffer_load_dwordx4 v26, s[12:15], s45 offen offset:0 nt lds
    s_add_u32 s45, s45, s16
    buffer_load_dwordx4 v27, s[12:15], s45 offen offset:1024 nt lds
    s_add_u32 s45, s45, s16
    buffer_load_dwordx4 v28, s[12:15], s45 offen offset:2048 nt lds
    s_add_u32 s45, s45, s16
    buffer_load_dwordx4 v29, s[12:15], s45 offen offset:3072 nt lds
    s_branch L1_q36
L1_q36x:
    s_add_u32 s45, s45, s16
    s_add_u32 s45, s45, 4096
    buffer_load_dwordx4 v26, s[12:15], s45 offen offset:0 lds
    s_add_u32 s45, s45, s16
    buffer_load_dwordx4 v27, s[12:15], s45 offen offset:1024 lds
    s_add_u32 s45, s45, s16
    buffer_load_dwordx4 v28, s[12:15], s45 offen offset:2048 lds
    s_add_u32 s45, s45, s16
    buffer_load_dwordx4 v29, s[12:15], s45 offen offset:3072 lds
L1_q36:
    s_waitcnt lgkmcnt(1)
    v_mfma_f32_32x32x16_bf16 v[48:63], a[100:103], a[112:115], v[48:63]
    ds_read_b64_tr_b16 a[104:105], v76 offset:4096
    ds_read_b64_tr_b16 a[106:107], v76 offset:5120
    ds_read_b64_tr_b16 a[108:109], v77 offset:4096
    ds_read_b64_tr_b16 a[110:111], v77 offset:5120
    s_waitcnt lgkmcnt(2)
    v_mfma_f32_32x32x16_bf16 v[32:47], a[104:107], a[116:119], v[32:47]
    ds_read_b128 a[112:115], v80 offset:16384
    ds_read_b64_tr_b16 a[96:97], v76 offset:8192
    ds_read_b64_tr_b16 a[98:99], v76 offset:9216
    s_waitcnt lgkmcnt(3)
    v_mfma_f32_32x32x16_bf16 v[48:63], a[108:111], a[116:119], v[48:63]
    ds_read_b64_tr_b16 a[100:101], v77 offset:8192
    ds_read_b64_tr_b16 a[102:103], v77 offset:9216
    s_waitcnt lgkmcnt(2)
    v_mfma_f32_32x32x16_bf16 v[32:47], a[96:99], a[112:115], v[32:47]
    ds_read_b128 a[116:119], v81 offset:16384
    ds_read_b64_tr_b16 a[104:105], v76 offset:12288
    ds_read_b64_tr_b16 a[106:107], v76 offset:13312
    s_waitcnt lgkmcnt(3)
    v_mfma_f32_32x32x16_bf16 v[48:63], a[100:103], a[112:115], v[48:63]
    ds_read_b64_tr_b16 a[108:109], v77 offset:12288
    ds_read_b64_tr_b16 a[110:111], v77 offset:13312
    s_waitcnt lgkmcnt(0)
    s_cbranch_vccz L1_q37
    s_waitcnt vmcnt(16)
L1_q37:
    s_barrier
    v_mfma_f32_32x32x16_bf16 v[32:47], a[104:107], a[116:119], v[32:47]
    ds_read_b128 a[112:115], v72 offset:49152
    s_cbranch_vccz L1_q38
    s_add_u32 s44, s43, 13
    s_and_b32 s44, s44, 15
    s_mul_i32 s45, s44, s17
    s_add_u32 s45, s45, s24
    s_mul_i32 s47, s55, 49152
    s_add_u32 s47, s47, s23
    s_add_u32 s46, s47, 32768
    s_mov_b32 m0, s46
    s_cmp_eq_u32 s20, 1
    s_cbranch_scc1 L1_q38x
    s_nop 0
    buffer_load_dwordx4 v26, s[12:15], s45 offen offset:0 nt lds
    s_add_u32 s45, s45, s16
    buffer_load_dwordx4 v27, s[12:15], s45 offen offset:1024 nt lds
    s_add_u32 s45, s45, s16
    buffer_load_dwordx4 v28, s[12:15], s45 offen offset:2048 nt lds
    s_add_u32 s45, s45, s16
    buffer_load_dwordx4 v29, s[12:15], s45 offen offset:3072 nt lds
    s_branch L1_q38
L1_q38x:
    s_nop 0
    buffer_load_dwordx4 v26, s[12:15], s45 offen offset:0 lds
    s_add_u32 s45, s45, s16
    buffer_load_dwordx4 v27, s[12:15], s45 offen offset:1024 lds
    s_add_u32 s45, s45, s16
    buffer_load_dwordx4 v28, s[12:15], s45 offen offset:2048 lds
    s_add_u32 s45, s45, s16
    buffer_load_dwordx4 v29, s[12:15], s45 offen offset:3072 lds
L1_q38:
    v_mfma_f32_32x32x16_bf16 v[48:63], a[108:111], a[116:119], v[48:63]
    ds_read_b64_tr_b16 a[96:97], v70 offset:32768
    ds_read_b64_tr_b16 a[98:99], v70 offset:33792
    ds_read_b64_tr_b16 a[100:101], v71 offset:32768
    ds_read_b64_tr_b16 a[102:103], v71 offset:33792
    s_waitcnt lgkmcnt(2)
    v_mfma_f32_32x32x16_bf16 v[32:47], a[96:99], a[112:115], v[32:47]
    ds_read_b128 a[116:119], v73 offset:49152
    s_cbranch_vccz L1_q39
    s_add_u32 s46, s47, 36864
    s_mov_b32 m0, s46
    s_cmp_eq_u32 s20, 1
    s_cbranch_scc1 L1_q39x
    s_add_u32 s45, s45, s16
    s_add_u32 s45, s45, 4096
    buffer_load_dwordx4 v26, s[12:15], s45 offen offset:0 nt lds
    s_add_u32 s45, s45, s16
    buffer_load_dwordx4 v27, s[12:15], s45 offen offset:1024 nt lds
    s_add_u32 s45, s45, s16
    buffer_load_dwordx4 v28, s[12:15], s45 offen offset:2048 nt lds
    s_add_u32 s45, s45, s16
    buffer_load_dwordx4 v29, s[12:15], s45 offen offset:3072 nt lds
    s_branch L1_q39
L1_q39x:
    s_add_u32 s45, s45, s16
    s_add_u32 s45, s45, 4096
    buffer_load_dwordx4 v26, s[12:15], s45 offen offset:0 lds
    s_add_u32 s45, s45, s16
    buffer_load_dwordx4 v27, s[12:15], s45 offen offset:1024 lds
    s_add_u32 s45, s45, s16
    buffer_load_dwordx4 v28, s[12:15], s45 offen offset:2048 lds
    s_add_u32 s45, s45, s16
    buffer_load_dwordx4 v29, s[12:15], s45 offen offset:3072 lds
L1_q39:
    s_waitcnt lgkmcnt(1)
    v_mfma_f32_32x32x16_bf16 v[48:63], a[100:103], a[112:115], v[48:63]
    ds_read_b64_tr_b16 a[104:105], v70 offset:36864
    ds_read_b64_tr_b16 a[106:107], v70 offset:37888
    ds_read_b64_tr_b16 a[108:109], v71 offset:36864
    ds_read_b64_tr_b16 a[110:111], v71 offset:37888
    s_waitcnt lgkmcnt(2)
    v_mfma_f32_32x32x16_bf16 v[32:47], a[104:107], a[116:119], v[32:47]
    ds_read_b128 a[112:115], v74 offset:49152
    ds_read_b64_tr_b16 a[96:97], v70 offset:40960
    ds_read_b64_tr_b16 a[98:99], v70 offset:41984
    s_waitcnt lgkmcnt(3)
    v_mfma_f32_32x32x16_bf16 v[48:63], a[108:111], a[116:119], v[48:63]
    ds_read_b64_tr_b16 a[100:101], v71 offset:40960
    ds_read_b64_tr_b16 a[102:103], v71 offset:41984
    s_waitcnt lgkmcnt(2)
    v_mfma_f32_32x32x16_bf16 v[32:47], a[96:99], a[112:115], v[32:47]
    ds_read_b128 a[116:119], v75 offset:49152
    ds_read_b64_tr_b16 a[104:105], v70 offset:45056
    ds_read_b64_tr_b16 a[106:107], v70 offset:46080
    s_waitcnt lgkmcnt(3)
    v_mfma_f32_32x32x16_bf16 v[48:63], a[100:103], a[112:115], v[48:63]
    ds_read_b64_tr_b16 a[108:109], v71 offset:45056
    ds_read_b64_tr_b16 a[110:111], v71 offset:46080
    s_waitcnt lgkmcnt(0)
    s_cbranch_vccz L1_q40
    s_waitcnt vmcnt(16)
L1_q40:
    s_barrier
    v_mfma_f32_32x32x16_bf16 v[32:47], a[104:107], a[116:119], v[32:47]
    ds_read_b128 a[112:115], v66 offset:49152
    s_cbranch_vccz L1_q41
    s_add_u32 s44, s43, 14
    s_and_b32 s44, s44, 15
    s_mul_i32 s45, s44, s17
    s_add_u32 s45, s45, s24
    s_mul_i32 s47, s55, 16384
    s_add_u32 s47, s47, s23
    s_add_u32 s46, s47, 131072
    s_mov_b32 m0, s46
    s_cmp_eq_u32 s20, 1
    s_cbranch_scc1 L1_q41x
    s_nop 0
    buffer_load_dwordx4 v26, s[12:15], s45 offen offset:0 nt lds
    s_add_u32 s45, s45, s16
    buffer_load_dwordx4 v27, s[12:15], s45 offen offset:1024 nt lds
    s_add_u32 s45, s45, s16
    buffer_load_dwordx4 v28, s[12:15], s45 offen offset:2048 nt lds
    s_add_u32 s45, s45, s16
    buffer_load_dwordx4 v29, s[12:15], s45 offen offset:3072 nt lds
    s_branch L1_q41
L1_q41x:
    s_nop 0
    buffer_load_dwordx4 v26, s[12:15], s45 offen offset:0 lds
    s_add_u32 s45, s45, s16
    buffer_load_dwordx4 v27, s[12:15], s45 offen offset:1024 lds
    s_add_u32 s45, s45, s16
    buffer_load_dwordx4 v28, s[12:15], s45 offen offset:2048 lds
    s_add_u32 s45, s45, s16
    buffer_load_dwordx4 v29, s[12:15], s45 offen offset:3072 lds
L1_q41:
    v_mfma_f32_32x32x16_bf16 v[48:63], a[108:111], a[116:119], v[48:63]
    ds_read_b64_tr_b16 a[96:97], v64 offset:0
    ds_read_b64_tr_b16 a[98:99], v64 offset:1024
    ds_read_b64_tr_b16 a[100:101], v65 offset:0
    ds_read_b64_tr_b16 a[102:103], v65 offset:1024
    s_waitcnt lgkmcnt(2)
    v_mfma_f32_32x32x16_bf16 v[32:47], a[96:99], a[112:115], v[32:47]
    ds_read_b128 a[116:119], v67 offset:49152
    s_cbranch_vccz L1_q42
    s_add_u32 s46, s47, 135168
    s_mov_b32 m0, s46
    s_cmp_eq_u32 s20, 1
    s_cbranch_scc1 L1_q42x
    s_add_u32 s45, s45, s16
    s_add_u32 s45, s45, 4096
    buffer_load_dwordx4 v26, s[12:15], s45 offen offset:0 nt lds
    s_add_u32 s45, s45, s16
    buffer_load_dwordx4 v27, s[12:15], s45 offen offset:1024 nt lds
    s_add_u32 s45, s45, s16
    buffer_load_dwordx4 v28, s[12:15], s45 offen offset:2048 nt lds
    s_add_u32 s45, s45, s16
    buffer_load_dwordx4 v29, s[12:15], s45 offen offset:3072 nt lds
    s_branch L1_q42
L1_q42x:
    s_add_u32 s45, s45, s16
    s_add_u32 s45, s45, 4096
    buffer_load_dwordx4 v26, s[12:15], s45 offen offset:0 lds
    s_add_u32 s45, s45, s16
    buffer_load_dwordx4 v27, s[12:15], s45 offen offset:1024 lds
    s_add_u32 s45, s45, s16
    buffer_load_dwordx4 v28, s[12:15], s45 offen offset:2048 lds
    s_add_u32 s45, s45, s16
    buffer_load_dwordx4 v29, s[12:15], s45 offen offset:3072 lds
L1_q42:
    s_waitcnt lgkmcnt(1)
    v_mfma_f32_32x32x16_bf16 v[48:63], a[100:103], a[112:115], v[48:63]
    ds_read_b64_tr_b16 a[104:105], v64 offset:4096
    ds_read_b64_tr_b16 a[106:107], v64 offset:5120
    ds_read_b64_tr_b16 a[108:109], v65 offset:4096
    ds_read_b64_tr_b16 a[110:111], v65 offset:5120
    s_waitcnt lgkmcnt(2)
    v_mfma_f32_32x32x16_bf16 v[32:47], a[104:107], a[116:119], v[32:47]
    ds_read_b128 a[112:115], v68 offset:49152
    ds_read_b64_tr_b16 a[96:97], v64 offset:8192
    ds_read_b64_tr_b16 a[98:99], v64 offset:9216
    s_waitcnt lgkmcnt(3)
    v_mfma_f32_32x32x16_bf16 v[48:63], a[108:111], a[116:119], v[48:63]
    ds_read_b64_tr_b16 a[100:101], v65 offset:8192
    ds_read_b64_tr_b16 a[102:103], v65 offset:9216
    s_waitcnt lgkmcnt(2)
    v_mfma_f32_32x32x16_bf16 v[32:47], a[96:99], a[112:115], v[32:47]
    ds_read_b128 a[116:119], v69 offset:49152
    ds_read_b64_tr_b16 a[104:105], v64 offset:12288
    ds_read_b64_tr_b16 a[106:107], v64 offset:13312
    s_waitcnt lgkmcnt(3)
    v_mfma_f32_32x32x16_bf16 v[48:63], a[100:103], a[112:115], v[48:63]
    ds_read_b64_tr_b16 a[108:109], v65 offset:12288
    ds_read_b64_tr_b16 a[110:111], v65 offset:13312
    s_waitcnt lgkmcnt(0)
    s_cbranch_vccz L1_q43
    s_waitcnt vmcnt(16)
L1_q43:
    s_barrier
    v_mfma_f32_32x32x16_bf16 v[32:47], a[104:107], a[116:119], v[32:47]
    ds_read_b128 a[112:115], v72 offset:0
    s_cbranch_vccz L1_q44
    s_add_u32 s44, s43, 15
    s_and_b32 s44, s44, 15
    s_mul_i32 s45, s44, s17
    s_add_u32 s45, s45, s24
    s_mul_i32 s47, s55, 16384
    s_add_u32 s47, s47, s23
    s_add_u32 s46, s47, 98304
    s_mov_b32 m0, s46
    s_cmp_eq_u32 s20, 1
    s_cbranch_scc1 L1_q44x
    s_nop 0
    buffer_load_dwordx4 v26, s[12:15], s45 offen offset:0 nt lds
    s_add_u32 s45, s45, s16
    buffer_load_dwordx4 v27, s[12:15], s45 offen offset:1024 nt lds
    s_add_u32 s45, s45, s16
    buffer_load_dwordx4 v28, s[12:15], s45 offen offset:2048 nt lds
    s_add_u32 s45, s45, s16
    buffer_load_dwordx4 v29, s[12:15], s45 offen offset:3072 nt lds
    s_branch L1_q44
L1_q44x:
    s_nop 0
    buffer_load_dwordx4 v26, s[12:15], s45 offen offset:0 lds
    s_add_u32 s45, s45, s16
    buffer_load_dwordx4 v27, s[12:15], s45 offen offset:1024 lds
    s_add_u32 s45, s45, s16
    buffer_load_dwordx4 v28, s[12:15], s45 offen offset:2048 lds
    s_add_u32 s45, s45, s16
    buffer_load_dwordx4 v29, s[12:15], s45 offen offset:3072 lds
L1_q44:
    ds_read_b64_tr_b16 a[96:97], v64 offset:16384
    ds_read_b64_tr_b16 a[98:99], v64 offset:17408
    v_mfma_f32_32x32x16_bf16 v[48:63], a[108:111], a[116:119], v[48:63]
    s_cbranch_vccz L1_q45
    s_add_u32 s46, s47, 102400
    s_mov_b32 m0, s46
    s_cmp_eq_u32 s20, 1
    s_cbranch_scc1 L1_q45x
    s_add_u32 s45, s45, s16
    s_add_u32 s45, s45, 4096
    buffer_load_dwordx4 v26, s[12:15], s45 offen offset:0 nt lds
    s_add_u32 s45, s45, s16
    buffer_load_dwordx4 v27, s[12:15], s45 offen offset:1024 nt lds
    s_add_u32 s45, s45, s16
    buffer_load_dwordx4 v28, s[12:15], s45 offen offset:2048 nt lds
    s_add_u32 s45, s45, s16
    buffer_load_dwordx4 v29, s[12:15], s45 offen offset:3072 nt lds
    s_branch L1_q45
L1_q45x:
    s_add_u32 s45, s45, s16
    s_add_u32 s45, s45, 4096
    buffer_load_dwordx4 v26, s[12:15], s45 offen offset:0 lds
    s_add_u32 s45, s45, s16
    buffer_load_dwordx4 v27, s[12:15], s45 offen offset:1024 lds
    s_add_u32 s45, s45, s16
    buffer_load_dwordx4 v28, s[12:15], s45 offen offset:2048 lds
    s_add_u32 s45, s45, s16
    buffer_load_dwordx4 v29, s[12:15], s45 offen offset:3072 lds
L1_q45:
    ds_read_b64_tr_b16 a[100:101], v65 offset:16384
    ds_read_b64_tr_b16 a[102:103], v65 offset:17408
    s_waitcnt lgkmcnt(2)
    v_mfma_f32_32x32x16_bf16 v[32:47], a[96:99], a[112:115], v[32:47]
    ds_read_b128 a[116:119], v73 offset:0
    s_cbranch_vccnz L1_q46
    s_add_u32 s46, s55, 0
    s_mov_b32 m0, s46
    s_add_u32 s45, s25, 0
    s_and_b32 s45, s45, 0x3ffff
    s_add_u32 s45, s45, s24
    buffer_load_dwordx4 v26, s[12:15], s45 offen offset:0 nt lds
    buffer_load_dwordx4 v27, s[12:15], s45 offen offset:1024 nt lds
    buffer_load_dwordx4 v28, s[12:15], s45 offen offset:2048 nt lds
    buffer_load_dwordx4 v29, s[12:15], s45 offen offset:3072 nt lds
L1_q46:
    s_waitcnt lgkmcnt(1)
    v_mfma_f32_32x32x16_bf16 v[48:63], a[100:103], a[112:115], v[48:63]
    ds_read_b64_tr_b16 a[104:105], v64 offset:20480
    ds_read_b64_tr_b16 a[106:107], v64 offset:21504
    ds_read_b64_tr_b16 a[108:109], v65 offset:20480
    ds_read_b64_tr_b16 a[110:111], v65 offset:21504
    s_waitcnt lgkmcnt(2)
    v_mfma_f32_32x32x16_bf16 v[32:47], a[104:107], a[116:119], v[32:47]
    ds_read_b128 a[112:115], v74 offset:0
    s_cbranch_vccnz L1_q47
    s_add_u32 s46, s55, 4096
    s_mov_b32 m0, s46
    s_add_u32 s45, s25, 0
    s_and_b32 s45, s45, 0x3ffff
    s_add_u32 s45, s45, s24
    s_add_u32 s45, s45, 4096
    buffer_load_dwordx4 v26, s[12:15], s45 offen offset:0 nt lds
    buffer_load_dwordx4 v27, s[12:15], s45 offen offset:1024 nt lds
    buffer_load_dwordx4 v28, s[12:15], s45 offen offset:2048 nt lds
    buffer_load_dwordx4 v29, s[12:15], s45 offen offset:3072 nt lds
L1_q47:
    s_waitcnt lgkmcnt(1)
    v_mfma_f32_32x32x16_bf16 v[48:63], a[108:111], a[116:119], v[48:63]
    ds_read_b64_tr_b16 a[96:97], v64 offset:24576
    ds_read_b64_tr_b16 a[98:99], v64 offset:25600
    ds_read_b64_tr_b16 a[100:101], v65 offset:24576
    ds_read_b64_tr_b16 a[102:103], v65 offset:25600
    s_waitcnt lgkmcnt(2)
    v_mfma_f32_32x32x16_bf16 v[32:47], a[96:99], a[112:115], v[32:47]
    ds_read_b128 a[116:119], v75 offset:0
    ds_read_b64_tr_b16 a[104:105], v64 offset:28672
    ds_read_b64_tr_b16 a[106:107], v64 offset:29696
    s_waitcnt lgkmcnt(3)
    v_mfma_f32_32x32x16_bf16 v[48:63], a[100:103], a[112:115], v[48:63]
    ds_read_b64_tr_b16 a[108:109], v65 offset:28672
    ds_read_b64_tr_b16 a[110:111], v65 offset:29696
    s_waitcnt lgkmcnt(0)
    s_cbranch_vccz L1_q48
    s_waitcnt vmcnt(16)
L1_q48:
    s_barrier
    v_mfma_f32_32x32x16_bf16 v[32:47], a[104:107], a[116:119], v[32:47]
    ds_read_b128 a[112:115], v72 offset:16384
    s_cbranch_vccnz L1_q49
    s_add_u32 s46, s55, 16384
    s_mov_b32 m0, s46
    s_add_u32 s45, s25, 16384
    s_and_b32 s45, s45, 0x3ffff
    s_add_u32 s45, s45, s24
    buffer_load_dwordx4 v26, s[12:15], s45 offen offset:0 nt lds
    buffer_load_dwordx4 v27, s[12:15], s45 offen offset:1024 nt lds
    buffer_load_dwordx4 v28, s[12:15], s45 offen offset:2048 nt lds
    buffer_load_dwordx4 v29, s[12:15], s45 offen offset:3072 nt lds
L1_q49:
    v_mfma_f32_32x32x16_bf16 v[48:63], a[108:111], a[116:119], v[48:63]
    ds_read_b64_tr_b16 a[96:97], v64 offset:32768
    ds_read_b64_tr_b16 a[98:99], v64 offset:33792
    ds_read_b64_tr_b16 a[100:101], v65 offset:32768
    ds_read_b64_tr_b16 a[102:103], v65 offset:33792
    s_waitcnt lgkmcnt(2)
    v_mfma_f32_32x32x16_bf16 v[32:47], a[96:99], a[112:115], v[32:47]
    ds_read_b128 a[116:119], v73 offset:16384
    s_cbranch_vccnz L1_q50
    s_add_u32 s46, s55, 20480
    s_mov_b32 m0, s46
    s_add_u32 s45, s25, 16384
    s_and_b32 s45, s45, 0x3ffff
    s_add_u32 s45, s45, s24
    s_add_u32 s45, s45, 4096
    buffer_load_dwordx4 v26, s[12:15], s45 offen offset:0 nt lds
    buffer_load_dwordx4 v27, s[12:15], s45 offen offset:1024 nt lds
    buffer_load_dwordx4 v28, s[12:15], s45 offen offset:2048 nt lds
    buffer_load_dwordx4 v29, s[12:15], s45 offen offset:3072 nt lds
L1_q50:
    s_waitcnt lgkmcnt(1)
    v_mfma_f32_32x32x16_bf16 v[48:63], a[100:103], a[112:115], v[48:63]
    ds_read_b64_tr_b16 a[104:105], v64 offset:36864
    ds_read_b64_tr_b16 a[106:107], v64 offset:37888
    ds_read_b64_tr_b16 a[108:109], v65 offset:36864
    ds_read_b64_tr_b16 a[110:111], v65 offset:37888
    s_waitcnt lgkmcnt(2)
    v_mfma_f32_32x32x16_bf16 v[32:47], a[104:107], a[116:119], v[32:47]
    ds_read_b128 a[112:115], v74 offset:16384
    ds_read_b64_tr_b16 a[96:97], v64 offset:40960
    ds_read_b64_tr_b16 a[98:99], v64 offset:41984
    s_waitcnt lgkmcnt(3)
    v_mfma_f32_32x32x16_bf16 v[48:63], a[108:111], a[116:119], v[48:63]
    ds_read_b64_tr_b16 a[100:101], v65 offset:40960
    ds_read_b64_tr_b16 a[102:103], v65 offset:41984
    s_waitcnt lgkmcnt(2)
    v_mfma_f32_32x32x16_bf16 v[32:47], a[96:99], a[112:115], v[32:47]
    ds_read_b128 a[116:119], v75 offset:16384
    ds_read_b64_tr_b16 a[104:105], v64 offset:45056
    ds_read_b64_tr_b16 a[106:107], v64 offset:46080
    s_waitcnt lgkmcnt(3)
    v_mfma_f32_32x32x16_bf16 v[48:63], a[100:103], a[112:115], v[48:63]
    ds_read_b64_tr_b16 a[108:109], v65 offset:45056
    ds_read_b64_tr_b16 a[110:111], v65 offset:46080
    s_waitcnt lgkmcnt(0)
    s_cbranch_vccz L1_q51
    s_waitcnt vmcnt(8)
L1_q51:
    s_barrier
    v_mfma_f32_32x32x16_bf16 v[32:47], a[104:107], a[116:119], v[32:47]
    ds_read_b128 a[112:115], v78 offset:16384
    s_cmp_lg_u32 s20, 2
    s_cbranch_scc1 L1_q52
    s_add_u32 s46, s55, 32768
    s_mov_b32 m0, s46
    s_add_u32 s45, s25, 32768
    s_and_b32 s45, s45, 0x3ffff
    s_add_u32 s45, s45, s24
    buffer_load_dwordx4 v26, s[12:15], s45 offen offset:0 nt lds
    buffer_load_dwordx4 v27, s[12:15], s45 offen offset:1024 nt lds
    buffer_load_dwordx4 v28, s[12:15], s45 offen offset:2048 nt lds
    buffer_load_dwordx4 v29, s[12:15], s45 offen offset:3072 nt lds
L1_q52:
    v_mfma_f32_32x32x16_bf16 v[48:63], a[108:111], a[116:119], v[48:63]
    ds_read_b64_tr_b16 a[96:97], v76 offset:0
    ds_read_b64_tr_b16 a[98:99], v76 offset:1024
    ds_read_b64_tr_b16 a[100:101], v77 offset:0
    ds_read_b64_tr_b16 a[102:103], v77 offset:1024
    s_waitcnt lgkmcnt(2)
    v_mfma_f32_32x32x16_bf16 v[32:47], a[96:99], a[112:115], v[32:47]
    ds_read_b128 a[116:119], v79 offset:16384
    s_cmp_lg_u32 s20, 2
    s_cbranch_scc1 L1_q53
    s_add_u32 s46, s55, 36864
    s_mov_b32 m0, s46
    s_add_u32 s45, s25, 32768
    s_and_b32 s45, s45, 0x3ffff
    s_add_u32 s45, s45, s24
    s_add_u32 s45, s45, 4096
    buffer_load_dwordx4 v26, s[12:15], s45 offen offset:0 nt lds
    buffer_load_dwordx4 v27, s[12:15], s45 offen offset:1024 nt lds
    buffer_load_dwordx4 v28, s[12:15], s45 offen offset:2048 nt lds
    buffer_load_dwordx4 v29, s[12:15], s45 offen offset:3072 nt lds
L1_q53:
    s_waitcnt lgkmcnt(1)
    v_mfma_f32_32x32x16_bf16 v[48:63], a[100:103], a[112:115], v[48:63]
    ds_read_b64_tr_b16 a[104:105], v76 offset:4096
    ds_read_b64_tr_b16 a[106:107], v76 offset:5120
    ds_read_b64_tr_b16 a[108:109], v77 offset:4096
    ds_read_b64_tr_b16 a[110:111], v77 offset:5120
    s_waitcnt lgkmcnt(2)
    v_mfma_f32_32x32x16_bf16 v[32:47], a[104:107], a[116:119], v[32:47]
    ds_read_b128 a[112:115], v80 offset:16384
    ds_read_b64_tr_b16 a[96:97], v76 offset:8192
    ds_read_b64_tr_b16 a[98:99], v76 offset:9216
    s_waitcnt lgkmcnt(3)
    v_mfma_f32_32x32x16_bf16 v[48:63], a[108:111], a[116:119], v[48:63]
    ds_read_b64_tr_b16 a[100:101], v77 offset:8192
    ds_read_b64_tr_b16 a[102:103], v77 offset:9216
    s_waitcnt lgkmcnt(2)
    v_mfma_f32_32x32x16_bf16 v[32:47], a[96:99], a[112:115], v[32:47]
    ds_read_b128 a[116:119], v81 offset:16384
    ds_read_b64_tr_b16 a[104:105], v76 offset:12288
    ds_read_b64_tr_b16 a[106:107], v76 offset:13312
    s_waitcnt lgkmcnt(3)
    v_mfma_f32_32x32x16_bf16 v[48:63], a[100:103], a[112:115], v[48:63]
    ds_read_b64_tr_b16 a[108:109], v77 offset:12288
    ds_read_b64_tr_b16 a[110:111], v77 offset:13312
    s_waitcnt lgkmcnt(0)
    s_cbranch_vccz L1_q54
    s_waitcnt vmcnt(0)
L1_q54:
    s_barrier
    v_mfma_f32_32x32x16_bf16 v[32:47], a[104:107], a[116:119], v[32:47]
    ds_read_b128 a[112:115], v72 offset:49152
    ds_read_b64_tr_b16 a[96:97], v70 offset:32768
    ds_read_b64_tr_b16 a[98:99], v70 offset:33792
    v_mfma_f32_32x32x16_bf16 v[48:63], a[108:111], a[116:119], v[48:63]
    ds_read_b64_tr_b16 a[100:101], v71 offset:32768
    ds_read_b64_tr_b16 a[102:103], v71 offset:33792
    s_waitcnt lgkmcnt(2)
    v_mfma_f32_32x32x16_bf16 v[32:47], a[96:99], a[112:115], v[32:47]
    ds_read_b128 a[116:119], v73 offset:49152
    ds_read_b64_tr_b16 a[104:105], v70 offset:36864
    ds_read_b64_tr_b16 a[106:107], v70 offset:37888
    s_waitcnt lgkmcnt(3)
    v_mfma_f32_32x32x16_bf16 v[48:63], a[100:103], a[112:115], v[48:63]
    ds_read_b64_tr_b16 a[108:109], v71 offset:36864
    ds_read_b64_tr_b16 a[110:111], v71 offset:37888
    s_waitcnt lgkmcnt(2)
    v_mfma_f32_32x32x16_bf16 v[32:47], a[104:107], a[116:119], v[32:47]
    ds_read_b128 a[112:115], v74 offset:49152
    ds_read_b64_tr_b16 a[96:97], v70 offset:40960
    ds_read_b64_tr_b16 a[98:99], v70 offset:41984
    s_waitcnt lgkmcnt(3)
    v_mfma_f32_32x32x16_bf16 v[48:63], a[108:111], a[116:119], v[48:63]
    ds_read_b64_tr_b16 a[100:101], v71 offset:40960
    ds_read_b64_tr_b16 a[102:103], v71 offset:41984
    s_waitcnt lgkmcnt(2)
    v_mfma_f32_32x32x16_bf16 v[32:47], a[96:99], a[112:115], v[32:47]
    ds_read_b128 a[116:119], v75 offset:49152
    ds_read_b64_tr_b16 a[104:105], v70 offset:45056
    ds_read_b64_tr_b16 a[106:107], v70 offset:46080
    s_waitcnt lgkmcnt(3)
    v_mfma_f32_32x32x16_bf16 v[48:63], a[100:103], a[112:115], v[48:63]
    ds_read_b64_tr_b16 a[108:109], v71 offset:45056
    ds_read_b64_tr_b16 a[110:111], v71 offset:46080
    s_waitcnt lgkmcnt(2)
    v_mfma_f32_32x32x16_bf16 v[32:47], a[104:107], a[116:119], v[32:47]
    s_waitcnt lgkmcnt(0)
    v_mfma_f32_32x32x16_bf16 v[48:63], a[108:111], a[116:119], v[48:63]
    v_accvgpr_write_b32 a0, 0
    v_accvgpr_write_b32 a1, 0
    v_accvgpr_write_b32 a2, 0
    v_accvgpr_write_b32 a3, 0
    v_accvgpr_write_b32 a4, 0
    v_accvgpr_write_b32 a5, 0
    v_accvgpr_write_b32 a6, 0
    v_accvgpr_write_b32 a7, 0
    v_accvgpr_write_b32 a8, 0
    v_accvgpr_write_b32 a9, 0
    v_accvgpr_write_b32 a10, 0
    v_accvgpr_write_b32 a11, 0
    v_accvgpr_write_b32 a12, 0
    v_accvgpr_write_b32 a13, 0
    v_accvgpr_write_b32 a14, 0
    v_accvgpr_write_b32 a15, 0
    v_accvgpr_write_b32 a16, 0
    v_accvgpr_write_b32 a17, 0
    v_accvgpr_write_b32 a18, 0
    v_accvgpr_write_b32 a19, 0
    v_accvgpr_write_b32 a20, 0
    v_accvgpr_write_b32 a21, 0
    v_accvgpr_write_b32 a22, 0
    v_accvgpr_write_b32 a23, 0
    v_accvgpr_write_b32 a24, 0
    v_accvgpr_write_b32 a25, 0
    v_accvgpr_write_b32 a26, 0
    v_accvgpr_write_b32 a27, 0
    v_accvgpr_write_b32 a28, 0
    v_accvgpr_write_b32 a29, 0
    v_accvgpr_write_b32 a30, 0
    v_accvgpr_write_b32 a31, 0
    v_accvgpr_write_b32 a32, 0
    v_accvgpr_write_b32 a33, 0
    v_accvgpr_write_b32 a34, 0
    v_accvgpr_write_b32 a35, 0
    v_accvgpr_write_b32 a36, 0
    v_accvgpr_write_b32 a37, 0
    v_accvgpr_write_b32 a38, 0
    v_accvgpr_write_b32 a39, 0
    v_accvgpr_write_b32 a40, 0
    v_accvgpr_write_b32 a41, 0
    v_accvgpr_write_b32 a42, 0
    v_accvgpr_write_b32 a43, 0
    v_accvgpr_write_b32 a44, 0
    v_accvgpr_write_b32 a45, 0
    v_accvgpr_write_b32 a46, 0
    v_accvgpr_write_b32 a47, 0
    v_accvgpr_write_b32 a48, 0
    v_accvgpr_write_b32 a49, 0
    v_accvgpr_write_b32 a50, 0
    v_accvgpr_write_b32 a51, 0
    v_accvgpr_write_b32 a52, 0
    v_accvgpr_write_b32 a53, 0
    v_accvgpr_write_b32 a54, 0
    v_accvgpr_write_b32 a55, 0
    v_accvgpr_write_b32 a56, 0
    v_accvgpr_write_b32 a57, 0
    v_accvgpr_write_b32 a58, 0
    v_accvgpr_write_b32 a59, 0
    v_accvgpr_write_b32 a60, 0
    v_accvgpr_write_b32 a61, 0
    v_accvgpr_write_b32 a62, 0
    v_accvgpr_write_b32 a63, 0
    s_lshl_b32 s44, s20, 13
    s_add_u32 s44, s44, 131072
    v_add_u32 v2, s44, v31
    s_lshl_b32 s45, s21, 12
    v_add_u32 v3, s45, v2
    v_mul_f32 v32, s53, v32
    v_mul_f32 v33, s53, v33
    v_mul_f32 v34, s53, v34
    v_mul_f32 v35, s53, v35
    v_mul_f32 v36, s53, v36
    v_mul_f32 v37, s53, v37
    v_mul_f32 v38, s53, v38
    v_mul_f32 v39, s53, v39
    v_mul_f32 v40, s53, v40
    v_mul_f32 v41, s53, v41
    v_mul_f32 v42, s53, v42
    v_mul_f32 v43, s53, v43
    v_mul_f32 v44, s53, v44
    v_mul_f32 v45, s53, v45
    v_mul_f32 v46, s53, v46
    v_mul_f32 v47, s53, v47
    v_mul_f32 v48, s53, v48
    v_mul_f32 v49, s53, v49
    v_mul_f32 v50, s53, v50
    v_mul_f32 v51, s53, v51
    v_mul_f32 v52, s53, v52
    v_mul_f32 v53, s53, v53
    v_mul_f32 v54, s53, v54
    v_mul_f32 v55, s53, v55
    v_mul_f32 v56, s53, v56
    v_mul_f32 v57, s53, v57
    v_mul_f32 v58, s53, v58
    v_mul_f32 v59, s53, v59
    v_mul_f32 v60, s53, v60
    v_mul_f32 v61, s53, v61
    v_mul_f32 v62, s53, v62
    v_mul_f32 v63, s53, v63
    v_cvt_pk_bf16_f32 v64, v32, v33
    v_cvt_pk_bf16_f32 v65, v34, v35
    v_cvt_pk_bf16_f32 v66, v36, v37
    v_cvt_pk_bf16_f32 v67, v38, v39
    v_cvt_pk_bf16_f32 v68, v40, v41
    v_cvt_pk_bf16_f32 v69, v42, v43
    v_cvt_pk_bf16_f32 v70, v44, v45
    v_cvt_pk_bf16_f32 v71, v46, v47
    v_cvt_pk_bf16_f32 v72, v48, v49
    v_cvt_pk_bf16_f32 v73, v50, v51
    v_cvt_pk_bf16_f32 v74, v52, v53
    v_cvt_pk_bf16_f32 v75, v54, v55
    v_cvt_pk_bf16_f32 v76, v56, v57
    v_cvt_pk_bf16_f32 v77, v58, v59
    v_cvt_pk_bf16_f32 v78, v60, v61
    v_cvt_pk_bf16_f32 v79, v62, v63
    ds_write_b128 v3, v[64:67] offset:0
    ds_write_b128 v3, v[68:71] offset:1024
    ds_write_b128 v3, v[72:75] offset:2048
    ds_write_b128 v3, v[76:79] offset:3072
    s_waitcnt lgkmcnt(0) vmcnt(8)
    s_barrier
    ds_read_b128 a[64:67], v2 offset:0
    ds_read_b128 a[68:71], v2 offset:1024
    ds_read_b128 a[72:75], v2 offset:2048
    ds_read_b128 a[76:79], v2 offset:3072
    ds_read_b128 a[80:83], v2 offset:4096
    ds_read_b128 a[84:87], v2 offset:5120
    ds_read_b128 a[88:91], v2 offset:6144
    ds_read_b128 a[92:95], v2 offset:7168
    ds_read_b128 a[96:99], v14 offset:0
    ds_read_b128 a[100:103], v15 offset:0
    ds_read_b128 a[104:107], v16 offset:0
    ds_read_b128 a[108:111], v17 offset:0
    ds_read_b128 a[112:115], v18 offset:0
    ds_read_b128 a[116:119], v19 offset:0
    ds_read_b128 a[120:123], v20 offset:0
    ds_read_b128 a[124:127], v21 offset:0
    s_waitcnt lgkmcnt(6)
    v_mfma_f32_32x32x16_bf16 v[32:47], a[96:99], a[64:67], 0
    v_mfma_f32_32x32x16_bf16 v[32:47], a[100:103], a[68:71], v[32:47]
    s_waitcnt lgkmcnt(4)
    v_mfma_f32_32x32x16_bf16 v[32:47], a[104:107], a[72:75], v[32:47]
    v_mfma_f32_32x32x16_bf16 v[32:47], a[108:111], a[76:79], v[32:47]
    s_waitcnt lgkmcnt(2)
    v_mfma_f32_32x32x16_bf16 v[32:47], a[112:115], a[80:83], v[32:47]
    v_mfma_f32_32x32x16_bf16 v[32:47], a[116:119], a[84:87], v[32:47]
    s_waitcnt lgkmcnt(0)
    v_mfma_f32_32x32x16_bf16 v[32:47], a[120:123], a[88:91], v[32:47]
    v_mfma_f32_32x32x16_bf16 v[32:47], a[124:127], a[92:95], v[32:47]
    ds_read_b128 a[96:99], v14 offset:16384
    ds_read_b128 a[100:103], v15 offset:16384
    ds_read_b128 a[104:107], v16 offset:16384
    ds_read_b128 a[108:111], v17 offset:16384
    ds_read_b128 a[112:115], v18 offset:16384
    ds_read_b128 a[116:119], v19 offset:16384
    ds_read_b128 a[120:123], v20 offset:16384
    ds_read_b128 a[124:127], v21 offset:16384
    s_nop 7
    v_max3_f32 v8, v32, v33, v34
    v_max3_f32 v8, v8, v35, v36
    v_max3_f32 v8, v8, v37, v38
    v_max3_f32 v8, v8, v39, v40
    v_max3_f32 v8, v8, v41, v42
    v_max3_f32 v8, v8, v43, v44
    v_max3_f32 v8, v8, v45, v46
    v_max_f32 v8, v8, v47
    v_mov_b32 v3, v8
    s_nop 1
    v_permlane32_swap_b32 v8, v3
    s_nop 1
    v_max_f32 v8, v8, v3
    v_sub_f32 v80, 0, v8
    v_sub_f32 v81, 0, v8
    v_sub_f32 v82, 0, v8
    v_sub_f32 v83, 0, v8
    v_sub_f32 v84, 0, v8
    v_sub_f32 v85, 0, v8
    v_sub_f32 v86, 0, v8
    v_sub_f32 v87, 0, v8
    v_sub_f32 v88, 0, v8
    v_sub_f32 v89, 0, v8
    v_sub_f32 v90, 0, v8
    v_sub_f32 v91, 0, v8
    v_sub_f32 v92, 0, v8
    v_sub_f32 v93, 0, v8
    v_sub_f32 v94, 0, v8
    v_sub_f32 v95, 0, v8
    v_sub_f32 v32, v32, v8
    v_sub_f32 v33, v33, v8
    v_sub_f32 v34, v34, v8
    v_sub_f32 v35, v35, v8
    v_sub_f32 v36, v36, v8
    v_sub_f32 v37, v37, v8
    v_sub_f32 v38, v38, v8
    v_sub_f32 v39, v39, v8
    v_sub_f32 v40, v40, v8
    v_sub_f32 v41, v41, v8
    v_sub_f32 v42, v42, v8
    v_sub_f32 v43, v43, v8
    v_sub_f32 v44, v44, v8
    v_sub_f32 v45, v45, v8
    v_sub_f32 v46, v46, v8
    v_sub_f32 v47, v47, v8
    v_mov_b32 v6, 0
    s_waitcnt lgkmcnt(0)
    s_waitcnt vmcnt(0)
    s_barrier
    s_add_u32 s46, s22, 0
    s_mov_b32 m0, s46
    s_add_u32 s45, s25, 49152
    s_and_b32 s45, s45, 0x3ffff
    buffer_load_dwordx4 v10, s[28:31], s45 offen offset:0 nt lds
    buffer_load_dwordx4 v11, s[28:31], s45 offen offset:1024 nt lds
    v_mfma_f32_32x32x16_bf16 v[48:63], a[96:99], a[64:67], v[80:95]
    v_exp_f32 v32, v32
    v_exp_f32 v33, v33
    v_mfma_f32_32x32x16_bf16 v[48:63], a[100:103], a[68:71], v[48:63]
    v_exp_f32 v34, v34
    v_add_f32 v6, v6, v32
    v_mfma_f32_32x32x16_bf16 v[48:63], a[104:107], a[72:75], v[48:63]
    v_exp_f32 v35, v35
    v_add_f32 v6, v6, v33
    v_cvt_pk_bf16_f32 v64, v32, v33
    v_mfma_f32_32x32x16_bf16 v[48:63], a[108:111], a[76:79], v[48:63]
    v_exp_f32 v36, v36
    v_add_f32 v6, v6, v34
    v_mfma_f32_32x32x16_bf16 v[48:63], a[112:115], a[80:83], v[48:63]
    v_exp_f32 v37, v37
    v_add_f32 v6, v6, v35
    v_cvt_pk_bf16_f32 v65, v34, v35
    v_mfma_f32_32x32x16_bf16 v[48:63], a[116:119], a[84:87], v[48:63]
    v_exp_f32 v38, v38
    v_add_f32 v6, v6, v36
    v_mfma_f32_32x32x16_bf16 v[48:63], a[120:123], a[88:91], v[48:63]
    v_exp_f32 v39, v39
    v_add_f32 v6, v6, v37
    v_cvt_pk_bf16_f32 v66, v36, v37
    v_mfma_f32_32x32x16_bf16 v[48:63], a[124:127], a[92:95], v[48:63]
    v_exp_f32 v40, v40
    v_add_f32 v6, v6, v38
    s_waitcnt lgkmcnt(0)
    s_barrier
    s_nop 7
    ds_read_b128 a[96:99], v14 offset:32768
    v_exp_f32 v41, v41
    ds_read_b128 a[100:103], v15 offset:32768
    v_add_f32 v6, v6, v39
    v_cvt_pk_bf16_f32 v67, v38, v39
    ds_read_b128 a[104:107], v16 offset:32768
    v_exp_f32 v42, v42
    ds_read_b128 a[108:111], v17 offset:32768
    v_add_f32 v6, v6, v40
    v_exp_f32 v43, v43
    ds_read_b128 a[112:115], v18 offset:32768
    ds_read_b128 a[116:119], v19 offset:32768
    v_add_f32 v6, v6, v41
    v_cvt_pk_bf16_f32 v68, v40, v41
    ds_read_b128 a[120:123], v20 offset:32768
    v_exp_f32 v44, v44
    ds_read_b128 a[124:127], v21 offset:32768
    v_add_f32 v6, v6, v42
    v_exp_f32 v45, v45
    s_add_u32 s46, s22, 16384
    s_mov_b32 m0, s46
    s_add_u32 s45, s25, 65536
    s_and_b32 s45, s45, 0x3ffff
    v_add_f32 v6, v6, v43
    v_cvt_pk_bf16_f32 v69, v42, v43
    buffer_load_dwordx4 v10, s[28:31], s45 offen offset:0 nt lds
    v_exp_f32 v46, v46
    v_add_f32 v6, v6, v44
    v_exp_f32 v47, v47
    buffer_load_dwordx4 v11, s[28:31], s45 offen offset:1024 nt lds
    v_add_f32 v6, v6, v45
    v_cvt_pk_bf16_f32 v70, v44, v45
    v_add_f32 v6, v6, v46
    s_add_u32 s46, s22, 81920
    s_mov_b32 m0, s46
    s_add_u32 s45, s25, 32768
    s_and_b32 s45, s45, 0x3ffff
    v_add_f32 v6, v6, v47
    v_cvt_pk_bf16_f32 v71, v46, v47
    v_max3_f32 v8, v48, v49, v50
    buffer_load_dwordx4 v12, s[32:35], s45 offen offset:0 nt lds
    v_max3_f32 v8, v8, v51, v52
    v_max3_f32 v8, v8, v53, v54
    v_max3_f32 v8, v8, v55, v56
    v_max3_f32 v8, v8, v57, v58
    buffer_load_dwordx4 v12, s[32:35], s45 offen offset:1024 nt lds
    v_max3_f32 v8, v8, v59, v60
    v_max3_f32 v8, v8, v61, v62
    v_max_f32 v8, v8, v63
    v_cmp_nge_f32 vcc, s52, v8
    s_cbranch_vccz L1_join1
    s_swappc_b64 s[60:61], s[58:59]
L1_join1:
    s_waitcnt lgkmcnt(6)
    v_mfma_f32_32x32x16_bf16 v[32:47], a[96:99], a[64:67], v[80:95]
    ds_read_b64_tr_b16 a[128:129], v22 offset:0
    v_exp_f32 v48, v48
    ds_read_b64_tr_b16 a[130:131], v22 offset:2048
    v_exp_f32 v49, v49
    v_mfma_f32_32x32x16_bf16 v[32:47], a[100:103], a[68:71], v[32:47]
    ds_read_b64_tr_b16 a[132:133], v23 offset:0
    v_exp_f32 v50, v50
    ds_read_b64_tr_b16 a[134:135], v23 offset:2048
    v_add_f32 v6, v6, v48
    s_waitcnt lgkmcnt(8)
    v_mfma_f32_32x32x16_bf16 v[32:47], a[104:107], a[72:75], v[32:47]
    ds_read_b64_tr_b16 a[136:137], v24 offset:0
    v_exp_f32 v51, v51
    ds_read_b64_tr_b16 a[138:139], v24 offset:2048
    v_add_f32 v6, v6, v49
    v_cvt_pk_bf16_f32 v72, v48, v49
    v_mfma_f32_32x32x16_bf16 v[32:47], a[108:111], a[76:79], v[32:47]
    ds_read_b64_tr_b16 a[140:141], v25 offset:0
    v_exp_f32 v52, v52
    ds_read_b64_tr_b16 a[142:143], v25 offset:2048
    v_add_f32 v6, v6, v50
    s_waitcnt lgkmcnt(10)
    v_mfma_f32_32x32x16_bf16 v[32:47], a[112:115], a[80:83], v[32:47]
    ds_read_b64_tr_b16 a[144:145], v22 offset:4096
    v_exp_f32 v53, v53
    ds_read_b64_tr_b16 a[146:147], v22 offset:6144
    v_add_f32 v6, v6, v51
    v_cvt_pk_bf16_f32 v73, v50, v51
    v_mfma_f32_32x32x16_bf16 v[32:47], a[116:119], a[84:87], v[32:47]
    ds_read_b64_tr_b16 a[148:149], v23 offset:4096
    v_exp_f32 v54, v54
    ds_read_b64_tr_b16 a[150:151], v23 offset:6144
    v_add_f32 v6, v6, v52
    s_waitcnt lgkmcnt(12)
    v_mfma_f32_32x32x16_bf16 v[32:47], a[120:123], a[88:91], v[32:47]
    ds_read_b64_tr_b16 a[152:153], v24 offset:4096
    v_exp_f32 v55, v55
    ds_read_b64_tr_b16 a[154:155], v24 offset:6144
    v_add_f32 v6, v6, v53
    v_cvt_pk_bf16_f32 v74, v52, v53
    v_mfma_f32_32x32x16_bf16 v[32:47], a[124:127], a[92:95], v[32:47]
    ds_read_b64_tr_b16 a[156:157], v25 offset:4096
    v_exp_f32 v56, v56
    ds_read_b64_tr_b16 a[158:159], v25 offset:6144
    v_add_f32 v6, v6, v54
    s_waitcnt lgkmcnt(0)
    v_mfma_f32_32x32x16_bf16 a[0:15], a[128:131], v[64:67], a[0:15]
    s_waitcnt vmcnt(4)
    s_barrier
    v_mfma_f32_32x32x16_bf16 a[16:31], a[132:135], v[64:67], a[16:31]
    ds_read_b128 a[96:99], v14 offset:0
    v_exp_f32 v57, v57
    ds_read_b128 a[100:103], v15 offset:0
    v_add_f32 v6, v6, v55
    v_cvt_pk_bf16_f32 v75, v54, v55
    ds_read_b128 a[104:107], v16 offset:0
    v_exp_f32 v58, v58
    v_mfma_f32_32x32x16_bf16 a[32:47], a[136:139], v[64:67], a[32:47]
    ds_read_b128 a[108:111], v17 offset:0
    v_add_f32 v6, v6, v56
    v_exp_f32 v59, v59
    ds_read_b128 a[112:115], v18 offset:0
    ds_read_b128 a[116:119], v19 offset:0
    v_add_f32 v6, v6, v57
    v_mfma_f32_32x32x16_bf16 a[48:63], a[140:143], v[64:67], a[48:63]
    v_cvt_pk_bf16_f32 v76, v56, v57
    ds_read_b128 a[120:123], v20 offset:0
    v_exp_f32 v60, v60
    ds_read_b128 a[124:127], v21 offset:0
    v_add_f32 v6, v6, v58
    v_exp_f32 v61, v61
    v_mfma_f32_32x32x16_bf16 a[0:15], a[144:147], v[68:71], a[0:15]
    s_add_u32 s46, s22, 32768
    s_mov_b32 m0, s46
    s_add_u32 s45, s25, 81920
    s_and_b32 s45, s45, 0x3ffff
    v_add_f32 v6, v6, v59
    v_cvt_pk_bf16_f32 v77, v58, v59
    buffer_load_dwordx4 v10, s[28:31], s45 offen offset:0 nt lds
    v_exp_f32 v62, v62
    v_mfma_f32_32x32x16_bf16 a[16:31], a[148:151], v[68:71], a[16:31]
    v_add_f32 v6, v6, v60
    v_exp_f32 v63, v63
    buffer_load_dwordx4 v11, s[28:31], s45 offen offset:1024 nt lds
    v_add_f32 v6, v6, v61
    v_cvt_pk_bf16_f32 v78, v60, v61
    v_add_f32 v6, v6, v62
    v_mfma_f32_32x32x16_bf16 a[32:47], a[152:155], v[68:71], a[32:47]
    s_add_u32 s46, s22, 49152
    s_mov_b32 m0, s46
    s_add_u32 s45, s25, 49152
    s_and_b32 s45, s45, 0x3ffff
    v_add_f32 v6, v6, v63
    v_cvt_pk_bf16_f32 v79, v62, v63
    v_max3_f32 v8, v32, v33, v34
    buffer_load_dwordx4 v12, s[32:35], s45 offen offset:0 nt lds
    v_max3_f32 v8, v8, v35, v36
    v_mfma_f32_32x32x16_bf16 a[48:63], a[156:159], v[68:71], a[48:63]
    v_max3_f32 v8, v8, v37, v38
    v_max3_f32 v8, v8, v39, v40
    v_max3_f32 v8, v8, v41, v42
    buffer_load_dwordx4 v12, s[32:35], s45 offen offset:1024 nt lds
    v_max3_f32 v8, v8, v43, v44
    v_max3_f32 v8, v8, v45, v46
    v_max_f32 v8, v8, v47
    v_cmp_nge_f32 vcc, s52, v8
    s_cbranch_vccz L1_join2
    s_swappc_b64 s[60:61], s[56:57]
L1_join2:
    s_waitcnt lgkmcnt(6)
    v_mfma_f32_32x32x16_bf16 v[48:63], a[96:99], a[64:67], v[80:95]
    ds_read_b64_tr_b16 a[128:129], v22 offset:16384
    v_exp_f32 v32, v32
    ds_read_b64_tr_b16 a[130:131], v22 offset:18432
    v_exp_f32 v33, v33
    v_mfma_f32_32x32x16_bf16 v[48:63], a[100:103], a[68:71], v[48:63]
    ds_read_b64_tr_b16 a[132:133], v23 offset:16384
    v_exp_f32 v34, v34
    ds_read_b64_tr_b16 a[134:135], v23 offset:18432
    v_add_f32 v6, v6, v32
    s_waitcnt lgkmcnt(8)
    v_mfma_f32_32x32x16_bf16 v[48:63], a[104:107], a[72:75], v[48:63]
    ds_read_b64_tr_b16 a[136:137], v24 offset:16384
    v_exp_f32 v35, v35
    ds_read_b64_tr_b16 a[138:139], v24 offset:18432
    v_add_f32 v6, v6, v33
    v_cvt_pk_bf16_f32 v64, v32, v33
    v_mfma_f32_32x32x16_bf16 v[48:63], a[108:111], a[76:79], v[48:63]
    ds_read_b64_tr_b16 a[140:141], v25 offset:16384
    v_exp_f32 v36, v36
    ds_read_b64_tr_b16 a[142:143], v25 offset:18432
    v_add_f32 v6, v6, v34
    s_waitcnt lgkmcnt(10)
    v_mfma_f32_32x32x16_bf16 v[48:63], a[112:115], a[80:83], v[48:63]
    ds_read_b64_tr_b16 a[144:145], v22 offset:20480
    v_exp_f32 v37, v37
    ds_read_b64_tr_b16 a[146:147], v22 offset:22528
    v_add_f32 v6, v6, v35
    v_cvt_pk_bf16_f32 v65, v34, v35
    v_mfma_f32_32x32x16_bf16 v[48:63], a[116:119], a[84:87], v[48:63]
    ds_read_b64_tr_b16 a[148:149], v23 offset:20480
    v_exp_f32 v38, v38
    ds_read_b64_tr_b16 a[150:151], v23 offset:22528
    v_add_f32 v6, v6, v36
    s_waitcnt lgkmcnt(12)
    v_mfma_f32_32x32x16_bf16 v[48:63], a[120:123], a[88:91], v[48:63]
    ds_read_b64_tr_b16 a[152:153], v24 offset:20480
    v_exp_f32 v39, v39
    ds_read_b64_tr_b16 a[154:155], v24 offset:22528
    v_add_f32 v6, v6, v37
    v_cvt_pk_bf16_f32 v66, v36, v37
    v_mfma_f32_32x32x16_bf16 v[48:63], a[124:127], a[92:95], v[48:63]
    ds_read_b64_tr_b16 a[156:157], v25 offset:20480
    v_exp_f32 v40, v40
    ds_read_b64_tr_b16 a[158:159], v25 offset:22528
    v_add_f32 v6, v6, v38
    s_waitcnt lgkmcnt(0)
    v_mfma_f32_32x32x16_bf16 a[0:15], a[128:131], v[72:75], a[0:15]
    s_waitcnt vmcnt(4)
    s_barrier
    v_mfma_f32_32x32x16_bf16 a[16:31], a[132:135], v[72:75], a[16:31]
    ds_read_b128 a[96:99], v14 offset:16384
    v_exp_f32 v41, v41
    ds_read_b128 a[100:103], v15 offset:16384
    v_add_f32 v6, v6, v39
    v_cvt_pk_bf16_f32 v67, v38, v39
    ds_read_b128 a[104:107], v16 offset:16384
    v_exp_f32 v42, v42
    v_mfma_f32_32x32x16_bf16 a[32:47], a[136:139], v[72:75], a[32:47]
    ds_read_b128 a[108:111], v17 offset:16384
    v_add_f32 v6, v6, v40
    v_exp_f32 v43, v43
    ds_read_b128 a[112:115], v18 offset:16384
    ds_read_b128 a[116:119], v19 offset:16384
    v_add_f32 v6, v6, v41
    v_mfma_f32_32x32x16_bf16 a[48:63], a[140:143], v[72:75], a[48:63]
    v_cvt_pk_bf16_f32 v68, v40, v41
    ds_read_b128 a[120:123], v20 offset:16384
    v_exp_f32 v44, v44
    ds_read_b128 a[124:127], v21 offset:16384
    v_add_f32 v6, v6, v42
    v_exp_f32 v45, v45
    v_mfma_f32_32x32x16_bf16 a[0:15], a[144:147], v[76:79], a[0:15]
    s_add_u32 s46, s22, 0
    s_mov_b32 m0, s46
    s_add_u32 s45, s25, 98304
    s_and_b32 s45, s45, 0x3ffff
    v_add_f32 v6, v6, v43
    v_cvt_pk_bf16_f32 v69, v42, v43
    buffer_load_dwordx4 v10, s[28:31], s45 offen offset:0 nt lds
    v_exp_f32 v46, v46
    v_mfma_f32_32x32x16_bf16 a[16:31], a[148:151], v[76:79], a[16:31]
    v_add_f32 v6, v6, v44
    v_exp_f32 v47, v47
    buffer_load_dwordx4 v11, s[28:31], s45 offen offset:1024 nt lds
    v_add_f32 v6, v6, v45
    v_cvt_pk_bf16_f32 v70, v44, v45
    v_add_f32 v6, v6, v46
    v_mfma_f32_32x32x16_bf16 a[32:47], a[152:155], v[76:79], a[32:47]
    s_add_u32 s46, s22, 65536
    s_mov_b32 m0, s46
    s_add_u32 s45, s25, 65536
    s_and_b32 s45, s45, 0x3ffff
    v_add_f32 v6, v6, v47
    v_cvt_pk_bf16_f32 v71, v46, v47
    v_max3_f32 v8, v48, v49, v50
    buffer_load_dwordx4 v12, s[32:35], s45 offen offset:0 nt lds
    v_max3_f32 v8, v8, v51, v52
    v_mfma_f32_32x32x16_bf16 a[48:63], a[156:159], v[76:79], a[48:63]
    v_max3_f32 v8, v8, v53, v54
    v_max3_f32 v8, v8, v55, v56
    v_max3_f32 v8, v8, v57, v58
    buffer_load_dwordx4 v12, s[32:35], s45 offen offset:1024 nt lds
    v_max3_f32 v8, v8, v59, v60
    v_max3_f32 v8, v8, v61, v62
    v_max_f32 v8, v8, v63
    v_cmp_nge_f32 vcc, s52, v8
    s_cbranch_vccz L1_join3
    s_swappc_b64 s[60:61], s[58:59]
L1_join3:
    s_waitcnt lgkmcnt(6)
    v_mfma_f32_32x32x16_bf16 v[32:47], a[96:99], a[64:67], v[80:95]
    ds_read_b64_tr_b16 a[128:129], v22 offset:32768
    v_exp_f32 v48, v48
    ds_read_b64_tr_b16 a[130:131], v22 offset:34816
    v_exp_f32 v49, v49
    v_mfma_f32_32x32x16_bf16 v[32:47], a[100:103], a[68:71], v[32:47]
    ds_read_b64_tr_b16 a[132:133], v23 offset:32768
    v_exp_f32 v50, v50
    ds_read_b64_tr_b16 a[134:135], v23 offset:34816
    v_add_f32 v6, v6, v48
    s_waitcnt lgkmcnt(8)
    v_mfma_f32_32x32x16_bf16 v[32:47], a[104:107], a[72:75], v[32:47]
    ds_read_b64_tr_b16 a[136:137], v24 offset:32768
    v_exp_f32 v51, v51
    ds_read_b64_tr_b16 a[138:139], v24 offset:34816
    v_add_f32 v6, v6, v49
    v_cvt_pk_bf16_f32 v72, v48, v49
    v_mfma_f32_32x32x16_bf16 v[32:47], a[108:111], a[76:79], v[32:47]
    ds_read_b64_tr_b16 a[140:141], v25 offset:32768
    v_exp_f32 v52, v52
    ds_read_b64_tr_b16 a[142:143], v25 offset:34816
    v_add_f32 v6, v6, v50
    s_waitcnt lgkmcnt(10)
    v_mfma_f32_32x32x16_bf16 v[32:47], a[112:115], a[80:83], v[32:47]
    ds_read_b64_tr_b16 a[144:145], v22 offset:36864
    v_exp_f32 v53, v53
    ds_read_b64_tr_b16 a[146:147], v22 offset:38912
    v_add_f32 v6, v6, v51
    v_cvt_pk_bf16_f32 v73, v50, v51
    v_mfma_f32_32x32x16_bf16 v[32:47], a[116:119], a[84:87], v[32:47]
    ds_read_b64_tr_b16 a[148:149], v23 offset:36864
    v_exp_f32 v54, v54
    ds_read_b64_tr_b16 a[150:151], v23 offset:38912
    v_add_f32 v6, v6, v52
    s_waitcnt lgkmcnt(12)
    v_mfma_f32_32x32x16_bf16 v[32:47], a[120:123], a[88:91], v[32:47]
    ds_read_b64_tr_b16 a[152:153], v24 offset:36864
    v_exp_f32 v55, v55
    ds_read_b64_tr_b16 a[154:155], v24 offset:38912
    v_add_f32 v6, v6, v53
    v_cvt_pk_bf16_f32 v74, v52, v53
    v_mfma_f32_32x32x16_bf16 v[32:47], a[124:127], a[92:95], v[32:47]
    ds_read_b64_tr_b16 a[156:157], v25 offset:36864
    v_exp_f32 v56, v56
    ds_read_b64_tr_b16 a[158:159], v25 offset:38912
    v_add_f32 v6, v6, v54
    s_waitcnt lgkmcnt(0)
    v_mfma_f32_32x32x16_bf16 a[0:15], a[128:131], v[64:67], a[0:15]
    s_waitcnt vmcnt(4)
    s_barrier
    v_mfma_f32_32x32x16_bf16 a[16:31], a[132:135], v[64:67], a[16:31]
    ds_read_b128 a[96:99], v14 offset:32768
    v_exp_f32 v57, v57
    ds_read_b128 a[100:103], v15 offset:32768
    v_add_f32 v6, v6, v55
    v_cvt_pk_bf16_f32 v75, v54, v55
    ds_read_b128 a[104:107], v16 offset:32768
    v_exp_f32 v58, v58
    v_mfma_f32_32x32x16_bf16 a[32:47], a[136:139], v[64:67], a[32:47]
    ds_read_b128 a[108:111], v17 offset:32768
    v_add_f32 v6, v6, v56
    v_exp_f32 v59, v59
    ds_read_b128 a[112:115], v18 offset:32768
    ds_read_b128 a[116:119], v19 offset:32768
    v_add_f32 v6, v6, v57
    v_mfma_f32_32x32x16_bf16 a[48:63], a[140:143], v[64:67], a[48:63]
    v_cvt_pk_bf16_f32 v76, v56, v57
    ds_read_b128 a[120:123], v20 offset:32768
    v_exp_f32 v60, v60
    ds_read_b128 a[124:127], v21 offset:32768
    v_add_f32 v6, v6, v58
    v_exp_f32 v61, v61
    v_mfma_f32_32x32x16_bf16 a[0:15], a[144:147], v[68:71], a[0:15]
    s_add_u32 s46, s22, 16384
    s_mov_b32 m0, s46
    s_add_u32 s45, s25, 114688
    s_and_b32 s45, s45, 0x3ffff
    v_add_f32 v6, v6, v59
    v_cvt_pk_bf16_f32 v77, v58, v59
    buffer_load_dwordx4 v10, s[28:31], s45 offen offset:0 nt lds
    v_exp_f32 v62, v62
    v_mfma_f32_32x32x16_bf16 a[16:31], a[148:151], v[68:71], a[16:31]
    v_add_f32 v6, v6, v60
    v_exp_f32 v63, v63
    buffer_load_dwordx4 v11, s[28:31], s45 offen offset:1024 nt lds
    v_add_f32 v6, v6, v61
    v_cvt_pk_bf16_f32 v78, v60, v61
    v_add_f32 v6, v6, v62
    v_mfma_f32_32x32x16_bf16 a[32:47], a[152:155], v[68:71], a[32:47]
    s_add_u32 s46, s22, 81920
    s_mov_b32 m0, s46
    s_add_u32 s45, s25, 81920
    s_and_b32 s45, s45, 0x3ffff
    v_add_f32 v6, v6, v63
    v_cvt_pk_bf16_f32 v79, v62, v63
    v_max3_f32 v8, v32, v33, v34
    buffer_load_dwordx4 v12, s[32:35], s45 offen offset:0 nt lds
    v_max3_f32 v8, v8, v35, v36
    v_mfma_f32_32x32x16_bf16 a[48:63], a[156:159], v[68:71], a[48:63]
    v_max3_f32 v8, v8, v37, v38
    v_max3_f32 v8, v8, v39, v40
    v_max3_f32 v8, v8, v41, v42
    buffer_load_dwordx4 v12, s[32:35], s45 offen offset:1024 nt lds
    v_max3_f32 v8, v8, v43, v44
    v_max3_f32 v8, v8, v45, v46
    v_max_f32 v8, v8, v47
    v_cmp_nge_f32 vcc, s52, v8
    s_cbranch_vccz L1_join4
    s_swappc_b64 s[60:61], s[56:57]
L1_join4:
    s_waitcnt lgkmcnt(6)
    v_mfma_f32_32x32x16_bf16 v[48:63], a[96:99], a[64:67], v[80:95]
    ds_read_b64_tr_b16 a[128:129], v22 offset:0
    v_exp_f32 v32, v32
    ds_read_b64_tr_b16 a[130:131], v22 offset:2048
    v_exp_f32 v33, v33
    v_mfma_f32_32x32x16_bf16 v[48:63], a[100:103], a[68:71], v[48:63]
    ds_read_b64_tr_b16 a[132:133], v23 offset:0
    v_exp_f32 v34, v34
    ds_read_b64_tr_b16 a[134:135], v23 offset:2048
    v_add_f32 v6, v6, v32
    s_waitcnt lgkmcnt(8)
    v_mfma_f32_32x32x16_bf16 v[48:63], a[104:107], a[72:75], v[48:63]
    ds_read_b64_tr_b16 a[136:137], v24 offset:0
    v_exp_f32 v35, v35
    ds_read_b64_tr_b16 a[138:139], v24 offset:2048
    v_add_f32 v6, v6, v33
    v_cvt_pk_bf16_f32 v64, v32, v33
    v_mfma_f32_32x32x16_bf16 v[48:63], a[108:111], a[76:79], v[48:63]
    ds_read_b64_tr_b16 a[140:141], v25 offset:0
    v_exp_f32 v36, v36
    ds_read_b64_tr_b16 a[142:143], v25 offset:2048
    v_add_f32 v6, v6, v34
    s_waitcnt lgkmcnt(10)
    v_mfma_f32_32x32x16_bf16 v[48:63], a[112:115], a[80:83], v[48:63]
    ds_read_b64_tr_b16 a[144:145], v22 offset:4096
    v_exp_f32 v37, v37
    ds_read_b64_tr_b16 a[146:147], v22 offset:6144
    v_add_f32 v6, v6, v35
    v_cvt_pk_bf16_f32 v65, v34, v35
    v_mfma_f32_32x32x16_bf16 v[48:63], a[116:119], a[84:87], v[48:63]
    ds_read_b64_tr_b16 a[148:149], v23 offset:4096
    v_exp_f32 v38, v38
    ds_read_b64_tr_b16 a[150:151], v23 offset:6144
    v_add_f32 v6, v6, v36
    s_waitcnt lgkmcnt(12)
    v_mfma_f32_32x32x16_bf16 v[48:63], a[120:123], a[88:91], v[48:63]
    ds_read_b64_tr_b16 a[152:153], v24 offset:4096
    v_exp_f32 v39, v39
    ds_read_b64_tr_b16 a[154:155], v24 offset:6144
    v_add_f32 v6, v6, v37
    v_cvt_pk_bf16_f32 v66, v36, v37
    v_mfma_f32_32x32x16_bf16 v[48:63], a[124:127], a[92:95], v[48:63]
    ds_read_b64_tr_b16 a[156:157], v25 offset:4096
    v_exp_f32 v40, v40
    ds_read_b64_tr_b16 a[158:159], v25 offset:6144
    v_add_f32 v6, v6, v38
    s_waitcnt lgkmcnt(0)
    v_mfma_f32_32x32x16_bf16 a[0:15], a[128:131], v[72:75], a[0:15]
    s_waitcnt vmcnt(4)
    s_barrier
    v_mfma_f32_32x32x16_bf16 a[16:31], a[132:135], v[72:75], a[16:31]
    ds_read_b128 a[96:99], v14 offset:0
    v_exp_f32 v41, v41
    ds_read_b128 a[100:103], v15 offset:0
    v_add_f32 v6, v6, v39
    v_cvt_pk_bf16_f32 v67, v38, v39
    ds_read_b128 a[104:107], v16 offset:0
    v_exp_f32 v42, v42
    v_mfma_f32_32x32x16_bf16 a[32:47], a[136:139], v[72:75], a[32:47]
    ds_read_b128 a[108:111], v17 offset:0
    v_add_f32 v6, v6, v40
    v_exp_f32 v43, v43
    ds_read_b128 a[112:115], v18 offset:0
    ds_read_b128 a[116:119], v19 offset:0
    v_add_f32 v6, v6, v41
    v_mfma_f32_32x32x16_bf16 a[48:63], a[140:143], v[72:75], a[48:63]
    v_cvt_pk_bf16_f32 v68, v40, v41
    ds_read_b128 a[120:123], v20 offset:0
    v_exp_f32 v44, v44
    ds_read_b128 a[124:127], v21 offset:0
    v_add_f32 v6, v6, v42
    v_exp_f32 v45, v45
    v_mfma_f32_32x32x16_bf16 a[0:15], a[144:147], v[76:79], a[0:15]
    s_add_u32 s46, s22, 32768
    s_mov_b32 m0, s46
    s_add_u32 s45, s25, 131072
    s_and_b32 s45, s45, 0x3ffff
    v_add_f32 v6, v6, v43
    v_cvt_pk_bf16_f32 v69, v42, v43
    buffer_load_dwordx4 v10, s[28:31], s45 offen offset:0 nt lds
    v_exp_f32 v46, v46
    v_mfma_f32_32x32x16_bf16 a[16:31], a[148:151], v[76:79], a[16:31]
    v_add_f32 v6, v6, v44
    v_exp_f32 v47, v47
    buffer_load_dwordx4 v11, s[28:31], s45 offen offset:1024 nt lds
    v_add_f32 v6, v6, v45
    v_cvt_pk_bf16_f32 v70, v44, v45
    v_add_f32 v6, v6, v46
    v_mfma_f32_32x32x16_bf16 a[32:47], a[152:155], v[76:79], a[32:47]
    s_add_u32 s46, s22, 49152
    s_mov_b32 m0, s46
    s_add_u32 s45, s25, 98304
    s_and_b32 s45, s45, 0x3ffff
    v_add_f32 v6, v6, v47
    v_cvt_pk_bf16_f32 v71, v46, v47
    v_max3_f32 v8, v48, v49, v50
    buffer_load_dwordx4 v12, s[32:35], s45 offen offset:0 nt lds
    v_max3_f32 v8, v8, v51, v52
    v_mfma_f32_32x32x16_bf16 a[48:63], a[156:159], v[76:79], a[48:63]
    v_max3_f32 v8, v8, v53, v54
    v_max3_f32 v8, v8, v55, v56
    v_max3_f32 v8, v8, v57, v58
    buffer_load_dwordx4 v12, s[32:35], s45 offen offset:1024 nt lds
    v_max3_f32 v8, v8, v59, v60
    v_max3_f32 v8, v8, v61, v62
    v_max_f32 v8, v8, v63
    v_cmp_nge_f32 vcc, s52, v8
    s_cbranch_vccz L1_join5
    s_swappc_b64 s[60:61], s[58:59]
L1_join5:
    s_waitcnt lgkmcnt(6)
    v_mfma_f32_32x32x16_bf16 v[32:47], a[96:99], a[64:67], v[80:95]
    ds_read_b64_tr_b16 a[128:129], v22 offset:16384
    v_exp_f32 v48, v48
    ds_read_b64_tr_b16 a[130:131], v22 offset:18432
    v_exp_f32 v49, v49
    v_mfma_f32_32x32x16_bf16 v[32:47], a[100:103], a[68:71], v[32:47]
    ds_read_b64_tr_b16 a[132:133], v23 offset:16384
    v_exp_f32 v50, v50
    ds_read_b64_tr_b16 a[134:135], v23 offset:18432
    v_add_f32 v6, v6, v48
    s_waitcnt lgkmcnt(8)
    v_mfma_f32_32x32x16_bf16 v[32:47], a[104:107], a[72:75], v[32:47]
    ds_read_b64_tr_b16 a[136:137], v24 offset:16384
    v_exp_f32 v51, v51
    ds_read_b64_tr_b16 a[138:139], v24 offset:18432
    v_add_f32 v6, v6, v49
    v_cvt_pk_bf16_f32 v72, v48, v49
    v_mfma_f32_32x32x16_bf16 v[32:47], a[108:111], a[76:79], v[32:47]
    ds_read_b64_tr_b16 a[140:141], v25 offset:16384
    v_exp_f32 v52, v52
    ds_read_b64_tr_b16 a[142:143], v25 offset:18432
    v_add_f32 v6, v6, v50
    s_waitcnt lgkmcnt(10)
    v_mfma_f32_32x32x16_bf16 v[32:47], a[112:115], a[80:83], v[32:47]
    ds_read_b64_tr_b16 a[144:145], v22 offset:20480
    v_exp_f32 v53, v53
    ds_read_b64_tr_b16 a[146:147], v22 offset:22528
    v_add_f32 v6, v6, v51
    v_cvt_pk_bf16_f32 v73, v50, v51
    v_mfma_f32_32x32x16_bf16 v[32:47], a[116:119], a[84:87], v[32:47]
    ds_read_b64_tr_b16 a[148:149], v23 offset:20480
    v_exp_f32 v54, v54
    ds_read_b64_tr_b16 a[150:151], v23 offset:22528
    v_add_f32 v6, v6, v52
    s_waitcnt lgkmcnt(12)
    v_mfma_f32_32x32x16_bf16 v[32:47], a[120:123], a[88:91], v[32:47]
    ds_read_b64_tr_b16 a[152:153], v24 offset:20480
    v_exp_f32 v55, v55
    ds_read_b64_tr_b16 a[154:155], v24 offset:22528
    v_add_f32 v6, v6, v53
    v_cvt_pk_bf16_f32 v74, v52, v53
    v_mfma_f32_32x32x16_bf16 v[32:47], a[124:127], a[92:95], v[32:47]
    ds_read_b64_tr_b16 a[156:157], v25 offset:20480
    v_exp_f32 v56, v56
    ds_read_b64_tr_b16 a[158:159], v25 offset:22528
    v_add_f32 v6, v6, v54
    s_waitcnt lgkmcnt(0)
    v_mfma_f32_32x32x16_bf16 a[0:15], a[128:131], v[64:67], a[0:15]
    s_waitcnt vmcnt(4)
    s_barrier
    v_mfma_f32_32x32x16_bf16 a[16:31], a[132:135], v[64:67], a[16:31]
    ds_read_b128 a[96:99], v14 offset:16384
    v_exp_f32 v57, v57
    ds_read_b128 a[100:103], v15 offset:16384
    v_add_f32 v6, v6, v55
    v_cvt_pk_bf16_f32 v75, v54, v55
    ds_read_b128 a[104:107], v16 offset:16384
    v_exp_f32 v58, v58
    v_mfma_f32_32x32x16_bf16 a[32:47], a[136:139], v[64:67], a[32:47]
    ds_read_b128 a[108:111], v17 offset:16384
    v_add_f32 v6, v6, v56
    v_exp_f32 v59, v59
    ds_read_b128 a[112:115], v18 offset:16384
    ds_read_b128 a[116:119], v19 offset:16384
    v_add_f32 v6, v6, v57
    v_mfma_f32_32x32x16_bf16 a[48:63], a[140:143], v[64:67], a[48:63]
    v_cvt_pk_bf16_f32 v76, v56, v57
    ds_read_b128 a[120:123], v20 offset:16384
    v_exp_f32 v60, v60
    ds_read_b128 a[124:127], v21 offset:16384
    v_add_f32 v6, v6, v58
    v_exp_f32 v61, v61
    v_mfma_f32_32x32x16_bf16 a[0:15], a[144:147], v[68:71], a[0:15]
    s_add_u32 s46, s22, 0
    s_mov_b32 m0, s46
    s_add_u32 s45, s25, 147456
    s_and_b32 s45, s45, 0x3ffff
    v_add_f32 v6, v6, v59
    v_cvt_pk_bf16_f32 v77, v58, v59
    buffer_load_dwordx4 v10, s[28:31], s45 offen offset:0 nt lds
    v_exp_f32 v62, v62
    v_mfma_f32_32x32x16_bf16 a[16:31], a[148:151], v[68:71], a[16:31]
    v_add_f32 v6, v6, v60
    v_exp_f32 v63, v63
    buffer_load_dwordx4 v11, s[28:31], s45 offen offset:1024 nt lds
    v_add_f32 v6, v6, v61
    v_cvt_pk_bf16_f32 v78, v60, v61
    v_add_f32 v6, v6, v62
    v_mfma_f32_32x32x16_bf16 a[32:47], a[152:155], v[68:71], a[32:47]
    s_add_u32 s46, s22, 65536
    s_mov_b32 m0, s46
    s_add_u32 s45, s25, 114688
    s_and_b32 s45, s45, 0x3ffff
    v_add_f32 v6, v6, v63
    v_cvt_pk_bf16_f32 v79, v62, v63
    v_max3_f32 v8, v32, v33, v34
    buffer_load_dwordx4 v12, s[32:35], s45 offen offset:0 nt lds
    v_max3_f32 v8, v8, v35, v36
    v_mfma_f32_32x32x16_bf16 a[48:63], a[156:159], v[68:71], a[48:63]
    v_max3_f32 v8, v8, v37, v38
    v_max3_f32 v8, v8, v39, v40
    v_max3_f32 v8, v8, v41, v42
    buffer_load_dwordx4 v12, s[32:35], s45 offen offset:1024 nt lds
    v_max3_f32 v8, v8, v43, v44
    v_max3_f32 v8, v8, v45, v46
    v_max_f32 v8, v8, v47
    v_cmp_nge_f32 vcc, s52, v8
    s_cbranch_vccz L1_join6
    s_swappc_b64 s[60:61], s[56:57]
L1_join6:
    s_waitcnt lgkmcnt(6)
    v_mfma_f32_32x32x16_bf16 v[48:63], a[96:99], a[64:67], v[80:95]
    ds_read_b64_tr_b16 a[128:129], v22 offset:32768
    v_exp_f32 v32, v32
    ds_read_b64_tr_b16 a[130:131], v22 offset:34816
    v_exp_f32 v33, v33
    v_mfma_f32_32x32x16_bf16 v[48:63], a[100:103], a[68:71], v[48:63]
    ds_read_b64_tr_b16 a[132:133], v23 offset:32768
    v_exp_f32 v34, v34
    ds_read_b64_tr_b16 a[134:135], v23 offset:34816
    v_add_f32 v6, v6, v32
    s_waitcnt lgkmcnt(8)
    v_mfma_f32_32x32x16_bf16 v[48:63], a[104:107], a[72:75], v[48:63]
    ds_read_b64_tr_b16 a[136:137], v24 offset:32768
    v_exp_f32 v35, v35
    ds_read_b64_tr_b16 a[138:139], v24 offset:34816
    v_add_f32 v6, v6, v33
    v_cvt_pk_bf16_f32 v64, v32, v33
    v_mfma_f32_32x32x16_bf16 v[48:63], a[108:111], a[76:79], v[48:63]
    ds_read_b64_tr_b16 a[140:141], v25 offset:32768
    v_exp_f32 v36, v36
    ds_read_b64_tr_b16 a[142:143], v25 offset:34816
    v_add_f32 v6, v6, v34
    s_waitcnt lgkmcnt(10)
    v_mfma_f32_32x32x16_bf16 v[48:63], a[112:115], a[80:83], v[48:63]
    ds_read_b64_tr_b16 a[144:145], v22 offset:36864
    v_exp_f32 v37, v37
    ds_read_b64_tr_b16 a[146:147], v22 offset:38912
    v_add_f32 v6, v6, v35
    v_cvt_pk_bf16_f32 v65, v34, v35
    v_mfma_f32_32x32x16_bf16 v[48:63], a[116:119], a[84:87], v[48:63]
    ds_read_b64_tr_b16 a[148:149], v23 offset:36864
    v_exp_f32 v38, v38
    ds_read_b64_tr_b16 a[150:151], v23 offset:38912
    v_add_f32 v6, v6, v36
    s_waitcnt lgkmcnt(12)
    v_mfma_f32_32x32x16_bf16 v[48:63], a[120:123], a[88:91], v[48:63]
    ds_read_b64_tr_b16 a[152:153], v24 offset:36864
    v_exp_f32 v39, v39
    ds_read_b64_tr_b16 a[154:155], v24 offset:38912
    v_add_f32 v6, v6, v37
    v_cvt_pk_bf16_f32 v66, v36, v37
    v_mfma_f32_32x32x16_bf16 v[48:63], a[124:127], a[92:95], v[48:63]
    ds_read_b64_tr_b16 a[156:157], v25 offset:36864
    v_exp_f32 v40, v40
    ds_read_b64_tr_b16 a[158:159], v25 offset:38912
    v_add_f32 v6, v6, v38
    s_waitcnt lgkmcnt(0)
    v_mfma_f32_32x32x16_bf16 a[0:15], a[128:131], v[72:75], a[0:15]
    s_waitcnt vmcnt(4)
    s_barrier
    v_mfma_f32_32x32x16_bf16 a[16:31], a[132:135], v[72:75], a[16:31]
    ds_read_b128 a[96:99], v14 offset:32768
    v_exp_f32 v41, v41
    ds_read_b128 a[100:103], v15 offset:32768
    v_add_f32 v6, v6, v39
    v_cvt_pk_bf16_f32 v67, v38, v39
    ds_read_b128 a[104:107], v16 offset:32768
    v_exp_f32 v42, v42
    v_mfma_f32_32x32x16_bf16 a[32:47], a[136:139], v[72:75], a[32:47]
    ds_read_b128 a[108:111], v17 offset:32768
    v_add_f32 v6, v6, v40
    v_exp_f32 v43, v43
    ds_read_b128 a[112:115], v18 offset:32768
    ds_read_b128 a[116:119], v19 offset:32768
    v_add_f32 v6, v6, v41
    v_mfma_f32_32x32x16_bf16 a[48:63], a[140:143], v[72:75], a[48:63]
    v_cvt_pk_bf16_f32 v68, v40, v41
    ds_read_b128 a[120:123], v20 offset:32768
    v_exp_f32 v44, v44
    ds_read_b128 a[124:127], v21 offset:32768
    v_add_f32 v6, v6, v42
    v_exp_f32 v45, v45
    v_mfma_f32_32x32x16_bf16 a[0:15], a[144:147], v[76:79], a[0:15]
    s_add_u32 s46, s22, 16384
    s_mov_b32 m0, s46
    s_add_u32 s45, s25, 163840
    s_and_b32 s45, s45, 0x3ffff
    v_add_f32 v6, v6, v43
    v_cvt_pk_bf16_f32 v69, v42, v43
    buffer_load_dwordx4 v10, s[28:31], s45 offen offset:0 nt lds
    v_exp_f32 v46, v46
    v_mfma_f32_32x32x16_bf16 a[16:31], a[148:151], v[76:79], a[16:31]
    v_add_f32 v6, v6, v44
    v_exp_f32 v47, v47
    buffer_load_dwordx4 v11, s[28:31], s45 offen offset:1024 nt lds
    v_add_f32 v6, v6, v45
    v_cvt_pk_bf16_f32 v70, v44, v45
    v_add_f32 v6, v6, v46
    v_mfma_f32_32x32x16_bf16 a[32:47], a[152:155], v[76:79], a[32:47]
    s_add_u32 s46, s22, 81920
    s_mov_b32 m0, s46
    s_add_u32 s45, s25, 131072
    s_and_b32 s45, s45, 0x3ffff
    v_add_f32 v6, v6, v47
    v_cvt_pk_bf16_f32 v71, v46, v47
    v_max3_f32 v8, v48, v49, v50
    buffer_load_dwordx4 v12, s[32:35], s45 offen offset:0 nt lds
    v_max3_f32 v8, v8, v51, v52
    v_mfma_f32_32x32x16_bf16 a[48:63], a[156:159], v[76:79], a[48:63]
    v_max3_f32 v8, v8, v53, v54
    v_max3_f32 v8, v8, v55, v56
    v_max3_f32 v8, v8, v57, v58
    buffer_load_dwordx4 v12, s[32:35], s45 offen offset:1024 nt lds
    v_max3_f32 v8, v8, v59, v60
    v_max3_f32 v8, v8, v61, v62
    v_max_f32 v8, v8, v63
    v_cmp_nge_f32 vcc, s52, v8
    s_cbranch_vccz L1_join7
    s_swappc_b64 s[60:61], s[58:59]
L1_join7:
    s_waitcnt lgkmcnt(6)
    v_mfma_f32_32x32x16_bf16 v[32:47], a[96:99], a[64:67], v[80:95]
    ds_read_b64_tr_b16 a[128:129], v22 offset:0
    v_exp_f32 v48, v48
    ds_read_b64_tr_b16 a[130:131], v22 offset:2048
    v_exp_f32 v49, v49
    v_mfma_f32_32x32x16_bf16 v[32:47], a[100:103], a[68:71], v[32:47]
    ds_read_b64_tr_b16 a[132:133], v23 offset:0
    v_exp_f32 v50, v50
    ds_read_b64_tr_b16 a[134:135], v23 offset:2048
    v_add_f32 v6, v6, v48
    s_waitcnt lgkmcnt(8)
    v_mfma_f32_32x32x16_bf16 v[32:47], a[104:107], a[72:75], v[32:47]
    ds_read_b64_tr_b16 a[136:137], v24 offset:0
    v_exp_f32 v51, v51
    ds_read_b64_tr_b16 a[138:139], v24 offset:2048
    v_add_f32 v6, v6, v49
    v_cvt_pk_bf16_f32 v72, v48, v49
    v_mfma_f32_32x32x16_bf16 v[32:47], a[108:111], a[76:79], v[32:47]
    ds_read_b64_tr_b16 a[140:141], v25 offset:0
    v_exp_f32 v52, v52
    ds_read_b64_tr_b16 a[142:143], v25 offset:2048
    v_add_f32 v6, v6, v50
    s_waitcnt lgkmcnt(10)
    v_mfma_f32_32x32x16_bf16 v[32:47], a[112:115], a[80:83], v[32:47]
    ds_read_b64_tr_b16 a[144:145], v22 offset:4096
    v_exp_f32 v53, v53
    ds_read_b64_tr_b16 a[146:147], v22 offset:6144
    v_add_f32 v6, v6, v51
    v_cvt_pk_bf16_f32 v73, v50, v51
    v_mfma_f32_32x32x16_bf16 v[32:47], a[116:119], a[84:87], v[32:47]
    ds_read_b64_tr_b16 a[148:149], v23 offset:4096
    v_exp_f32 v54, v54
    ds_read_b64_tr_b16 a[150:151], v23 offset:6144
    v_add_f32 v6, v6, v52
    s_waitcnt lgkmcnt(12)
    v_mfma_f32_32x32x16_bf16 v[32:47], a[120:123], a[88:91], v[32:47]
    ds_read_b64_tr_b16 a[152:153], v24 offset:4096
    v_exp_f32 v55, v55
    ds_read_b64_tr_b16 a[154:155], v24 offset:6144
    v_add_f32 v6, v6, v53
    v_cvt_pk_bf16_f32 v74, v52, v53
    v_mfma_f32_32x32x16_bf16 v[32:47], a[124:127], a[92:95], v[32:47]
    ds_read_b64_tr_b16 a[156:157], v25 offset:4096
    v_exp_f32 v56, v56
    ds_read_b64_tr_b16 a[158:159], v25 offset:6144
    v_add_f32 v6, v6, v54
    s_waitcnt lgkmcnt(0)
    v_mfma_f32_32x32x16_bf16 a[0:15], a[128:131], v[64:67], a[0:15]
    s_waitcnt vmcnt(4)
    s_barrier
    v_mfma_f32_32x32x16_bf16 a[16:31], a[132:135], v[64:67], a[16:31]
    ds_read_b128 a[96:99], v14 offset:0
    v_exp_f32 v57, v57
    ds_read_b128 a[100:103], v15 offset:0
    v_add_f32 v6, v6, v55
    v_cvt_pk_bf16_f32 v75, v54, v55
    ds_read_b128 a[104:107], v16 offset:0
    v_exp_f32 v58, v58
    v_mfma_f32_32x32x16_bf16 a[32:47], a[136:139], v[64:67], a[32:47]
    ds_read_b128 a[108:111], v17 offset:0
    v_add_f32 v6, v6, v56
    v_exp_f32 v59, v59
    ds_read_b128 a[112:115], v18 offset:0
    ds_read_b128 a[116:119], v19 offset:0
    v_add_f32 v6, v6, v57
    v_mfma_f32_32x32x16_bf16 a[48:63], a[140:143], v[64:67], a[48:63]
    v_cvt_pk_bf16_f32 v76, v56, v57
    ds_read_b128 a[120:123], v20 offset:0
    v_exp_f32 v60, v60
    ds_read_b128 a[124:127], v21 offset:0
    v_add_f32 v6, v6, v58
    v_exp_f32 v61, v61
    v_mfma_f32_32x32x16_bf16 a[0:15], a[144:147], v[68:71], a[0:15]
    s_add_u32 s46, s22, 32768
    s_mov_b32 m0, s46
    s_add_u32 s45, s25, 180224
    s_and_b32 s45, s45, 0x3ffff
    v_add_f32 v6, v6, v59
    v_cvt_pk_bf16_f32 v77, v58, v59
    buffer_load_dwordx4 v10, s[28:31], s45 offen offset:0 nt lds
    v_exp_f32 v62, v62
    v_mfma_f32_32x32x16_bf16 a[16:31], a[148:151], v[68:71], a[16:31]
    v_add_f32 v6, v6, v60
    v_exp_f32 v63, v63
    buffer_load_dwordx4 v11, s[28:31], s45 offen offset:1024 nt lds
    v_add_f32 v6, v6, v61
    v_cvt_pk_bf16_f32 v78, v60, v61
    v_add_f32 v6, v6, v62
    v_mfma_f32_32x32x16_bf16 a[32:47], a[152:155], v[68:71], a[32:47]
    s_add_u32 s46, s22, 49152
    s_mov_b32 m0, s46
    s_add_u32 s45, s25, 147456
    s_and_b32 s45, s45, 0x3ffff
    v_add_f32 v6, v6, v63
    v_cvt_pk_bf16_f32 v79, v62, v63
    v_max3_f32 v8, v32, v33, v34
    buffer_load_dwordx4 v12, s[32:35], s45 offen offset:0 nt lds
    v_max3_f32 v8, v8, v35, v36
    v_mfma_f32_32x32x16_bf16 a[48:63], a[156:159], v[68:71], a[48:63]
    v_max3_f32 v8, v8, v37, v38
    v_max3_f32 v8, v8, v39, v40
    v_max3_f32 v8, v8, v41, v42
    buffer_load_dwordx4 v12, s[32:35], s45 offen offset:1024 nt lds
    v_max3_f32 v8, v8, v43, v44
    v_max3_f32 v8, v8, v45, v46
    v_max_f32 v8, v8, v47
    v_cmp_nge_f32 vcc, s52, v8
    s_cbranch_vccz L1_join8
    s_swappc_b64 s[60:61], s[56:57]
L1_join8:
    s_waitcnt lgkmcnt(6)
    v_mfma_f32_32x32x16_bf16 v[48:63], a[96:99], a[64:67], v[80:95]
    ds_read_b64_tr_b16 a[128:129], v22 offset:16384
    v_exp_f32 v32, v32
    ds_read_b64_tr_b16 a[130:131], v22 offset:18432
    v_exp_f32 v33, v33
    v_mfma_f32_32x32x16_bf16 v[48:63], a[100:103], a[68:71], v[48:63]
    ds_read_b64_tr_b16 a[132:133], v23 offset:16384
    v_exp_f32 v34, v34
    ds_read_b64_tr_b16 a[134:135], v23 offset:18432
    v_add_f32 v6, v6, v32
    s_waitcnt lgkmcnt(8)
    v_mfma_f32_32x32x16_bf16 v[48:63], a[104:107], a[72:75], v[48:63]
    ds_read_b64_tr_b16 a[136:137], v24 offset:16384
    v_exp_f32 v35, v35
    ds_read_b64_tr_b16 a[138:139], v24 offset:18432
    v_add_f32 v6, v6, v33
    v_cvt_pk_bf16_f32 v64, v32, v33
    v_mfma_f32_32x32x16_bf16 v[48:63], a[108:111], a[76:79], v[48:63]
    ds_read_b64_tr_b16 a[140:141], v25 offset:16384
    v_exp_f32 v36, v36
    ds_read_b64_tr_b16 a[142:143], v25 offset:18432
    v_add_f32 v6, v6, v34
    s_waitcnt lgkmcnt(10)
    v_mfma_f32_32x32x16_bf16 v[48:63], a[112:115], a[80:83], v[48:63]
    ds_read_b64_tr_b16 a[144:145], v22 offset:20480
    v_exp_f32 v37, v37
    ds_read_b64_tr_b16 a[146:147], v22 offset:22528
    v_add_f32 v6, v6, v35
    v_cvt_pk_bf16_f32 v65, v34, v35
    v_mfma_f32_32x32x16_bf16 v[48:63], a[116:119], a[84:87], v[48:63]
    ds_read_b64_tr_b16 a[148:149], v23 offset:20480
    v_exp_f32 v38, v38
    ds_read_b64_tr_b16 a[150:151], v23 offset:22528
    v_add_f32 v6, v6, v36
    s_waitcnt lgkmcnt(12)
    v_mfma_f32_32x32x16_bf16 v[48:63], a[120:123], a[88:91], v[48:63]
    ds_read_b64_tr_b16 a[152:153], v24 offset:20480
    v_exp_f32 v39, v39
    ds_read_b64_tr_b16 a[154:155], v24 offset:22528
    v_add_f32 v6, v6, v37
    v_cvt_pk_bf16_f32 v66, v36, v37
    v_mfma_f32_32x32x16_bf16 v[48:63], a[124:127], a[92:95], v[48:63]
    ds_read_b64_tr_b16 a[156:157], v25 offset:20480
    v_exp_f32 v40, v40
    ds_read_b64_tr_b16 a[158:159], v25 offset:22528
    v_add_f32 v6, v6, v38
    s_waitcnt lgkmcnt(0)
    v_mfma_f32_32x32x16_bf16 a[0:15], a[128:131], v[72:75], a[0:15]
    s_waitcnt vmcnt(4)
    s_barrier
    v_mfma_f32_32x32x16_bf16 a[16:31], a[132:135], v[72:75], a[16:31]
    ds_read_b128 a[96:99], v14 offset:16384
    v_exp_f32 v41, v41
    ds_read_b128 a[100:103], v15 offset:16384
    v_add_f32 v6, v6, v39
    v_cvt_pk_bf16_f32 v67, v38, v39
    ds_read_b128 a[104:107], v16 offset:16384
    v_exp_f32 v42, v42
    v_mfma_f32_32x32x16_bf16 a[32:47], a[136:139], v[72:75], a[32:47]
    ds_read_b128 a[108:111], v17 offset:16384
    v_add_f32 v6, v6, v40
    v_exp_f32 v43, v43
    ds_read_b128 a[112:115], v18 offset:16384
    ds_read_b128 a[116:119], v19 offset:16384
    v_add_f32 v6, v6, v41
    v_mfma_f32_32x32x16_bf16 a[48:63], a[140:143], v[72:75], a[48:63]
    v_cvt_pk_bf16_f32 v68, v40, v41
    ds_read_b128 a[120:123], v20 offset:16384
    v_exp_f32 v44, v44
    ds_read_b128 a[124:127], v21 offset:16384
    v_add_f32 v6, v6, v42
    v_exp_f32 v45, v45
    v_mfma_f32_32x32x16_bf16 a[0:15], a[144:147], v[76:79], a[0:15]
    s_add_u32 s46, s22, 0
    s_mov_b32 m0, s46
    s_add_u32 s45, s25, 196608
    s_and_b32 s45, s45, 0x3ffff
    v_add_f32 v6, v6, v43
    v_cvt_pk_bf16_f32 v69, v42, v43
    buffer_load_dwordx4 v10, s[28:31], s45 offen offset:0 nt lds
    v_exp_f32 v46, v46
    v_mfma_f32_32x32x16_bf16 a[16:31], a[148:151], v[76:79], a[16:31]
    v_add_f32 v6, v6, v44
    v_exp_f32 v47, v47
    buffer_load_dwordx4 v11, s[28:31], s45 offen offset:1024 nt lds
    v_add_f32 v6, v6, v45
    v_cvt_pk_bf16_f32 v70, v44, v45
    v_add_f32 v6, v6, v46
    v_mfma_f32_32x32x16_bf16 a[32:47], a[152:155], v[76:79], a[32:47]
    s_add_u32 s46, s22, 65536
    s_mov_b32 m0, s46
    s_add_u32 s45, s25, 163840
    s_and_b32 s45, s45, 0x3ffff
    v_add_f32 v6, v6, v47
    v_cvt_pk_bf16_f32 v71, v46, v47
    v_max3_f32 v8, v48, v49, v50
    buffer_load_dwordx4 v12, s[32:35], s45 offen offset:0 nt lds
    v_max3_f32 v8, v8, v51, v52
    v_mfma_f32_32x32x16_bf16 a[48:63], a[156:159], v[76:79], a[48:63]
    v_max3_f32 v8, v8, v53, v54
    v_max3_f32 v8, v8, v55, v56
    v_max3_f32 v8, v8, v57, v58
    buffer_load_dwordx4 v12, s[32:35], s45 offen offset:1024 nt lds
    v_max3_f32 v8, v8, v59, v60
    v_max3_f32 v8, v8, v61, v62
    v_max_f32 v8, v8, v63
    v_cmp_nge_f32 vcc, s52, v8
    s_cbranch_vccz L1_join9
    s_swappc_b64 s[60:61], s[58:59]
L1_join9:
    s_waitcnt lgkmcnt(6)
    v_mfma_f32_32x32x16_bf16 v[32:47], a[96:99], a[64:67], v[80:95]
    ds_read_b64_tr_b16 a[128:129], v22 offset:32768
    v_exp_f32 v48, v48
    ds_read_b64_tr_b16 a[130:131], v22 offset:34816
    v_exp_f32 v49, v49
    v_mfma_f32_32x32x16_bf16 v[32:47], a[100:103], a[68:71], v[32:47]
    ds_read_b64_tr_b16 a[132:133], v23 offset:32768
    v_exp_f32 v50, v50
    ds_read_b64_tr_b16 a[134:135], v23 offset:34816
    v_add_f32 v6, v6, v48
    s_waitcnt lgkmcnt(8)
    v_mfma_f32_32x32x16_bf16 v[32:47], a[104:107], a[72:75], v[32:47]
    ds_read_b64_tr_b16 a[136:137], v24 offset:32768
    v_exp_f32 v51, v51
    ds_read_b64_tr_b16 a[138:139], v24 offset:34816
    v_add_f32 v6, v6, v49
    v_cvt_pk_bf16_f32 v72, v48, v49
    v_mfma_f32_32x32x16_bf16 v[32:47], a[108:111], a[76:79], v[32:47]
    ds_read_b64_tr_b16 a[140:141], v25 offset:32768
    v_exp_f32 v52, v52
    ds_read_b64_tr_b16 a[142:143], v25 offset:34816
    v_add_f32 v6, v6, v50
    s_waitcnt lgkmcnt(10)
    v_mfma_f32_32x32x16_bf16 v[32:47], a[112:115], a[80:83], v[32:47]
    ds_read_b64_tr_b16 a[144:145], v22 offset:36864
    v_exp_f32 v53, v53
    ds_read_b64_tr_b16 a[146:147], v22 offset:38912
    v_add_f32 v6, v6, v51
    v_cvt_pk_bf16_f32 v73, v50, v51
    v_mfma_f32_32x32x16_bf16 v[32:47], a[116:119], a[84:87], v[32:47]
    ds_read_b64_tr_b16 a[148:149], v23 offset:36864
    v_exp_f32 v54, v54
    ds_read_b64_tr_b16 a[150:151], v23 offset:38912
    v_add_f32 v6, v6, v52
    s_waitcnt lgkmcnt(12)
    v_mfma_f32_32x32x16_bf16 v[32:47], a[120:123], a[88:91], v[32:47]
    ds_read_b64_tr_b16 a[152:153], v24 offset:36864
    v_exp_f32 v55, v55
    ds_read_b64_tr_b16 a[154:155], v24 offset:38912
    v_add_f32 v6, v6, v53
    v_cvt_pk_bf16_f32 v74, v52, v53
    v_mfma_f32_32x32x16_bf16 v[32:47], a[124:127], a[92:95], v[32:47]
    ds_read_b64_tr_b16 a[156:157], v25 offset:36864
    v_exp_f32 v56, v56
    ds_read_b64_tr_b16 a[158:159], v25 offset:38912
    v_add_f32 v6, v6, v54
    s_waitcnt lgkmcnt(0)
    v_mfma_f32_32x32x16_bf16 a[0:15], a[128:131], v[64:67], a[0:15]
    s_waitcnt vmcnt(4)
    s_barrier
    v_mfma_f32_32x32x16_bf16 a[16:31], a[132:135], v[64:67], a[16:31]
    ds_read_b128 a[96:99], v14 offset:32768
    v_exp_f32 v57, v57
    ds_read_b128 a[100:103], v15 offset:32768
    v_add_f32 v6, v6, v55
    v_cvt_pk_bf16_f32 v75, v54, v55
    ds_read_b128 a[104:107], v16 offset:32768
    v_exp_f32 v58, v58
    v_mfma_f32_32x32x16_bf16 a[32:47], a[136:139], v[64:67], a[32:47]
    ds_read_b128 a[108:111], v17 offset:32768
    v_add_f32 v6, v6, v56
    v_exp_f32 v59, v59
    ds_read_b128 a[112:115], v18 offset:32768
    ds_read_b128 a[116:119], v19 offset:32768
    v_add_f32 v6, v6, v57
    v_mfma_f32_32x32x16_bf16 a[48:63], a[140:143], v[64:67], a[48:63]
    v_cvt_pk_bf16_f32 v76, v56, v57
    ds_read_b128 a[120:123], v20 offset:32768
    v_exp_f32 v60, v60
    ds_read_b128 a[124:127], v21 offset:32768
    v_add_f32 v6, v6, v58
    v_exp_f32 v61, v61
    v_mfma_f32_32x32x16_bf16 a[0:15], a[144:147], v[68:71], a[0:15]
    s_add_u32 s46, s22, 16384
    s_mov_b32 m0, s46
    s_add_u32 s45, s25, 212992
    s_and_b32 s45, s45, 0x3ffff
    v_add_f32 v6, v6, v59
    v_cvt_pk_bf16_f32 v77, v58, v59
    buffer_load_dwordx4 v10, s[28:31], s45 offen offset:0 nt lds
    v_exp_f32 v62, v62
    v_mfma_f32_32x32x16_bf16 a[16:31], a[148:151], v[68:71], a[16:31]
    v_add_f32 v6, v6, v60
    v_exp_f32 v63, v63
    buffer_load_dwordx4 v11, s[28:31], s45 offen offset:1024 nt lds
    v_add_f32 v6, v6, v61
    v_cvt_pk_bf16_f32 v78, v60, v61
    v_add_f32 v6, v6, v62
    v_mfma_f32_32x32x16_bf16 a[32:47], a[152:155], v[68:71], a[32:47]
    s_add_u32 s46, s22, 81920
    s_mov_b32 m0, s46
    s_add_u32 s45, s25, 180224
    s_and_b32 s45, s45, 0x3ffff
    v_add_f32 v6, v6, v63
    v_cvt_pk_bf16_f32 v79, v62, v63
    v_max3_f32 v8, v32, v33, v34
    buffer_load_dwordx4 v12, s[32:35], s45 offen offset:0 nt lds
    v_max3_f32 v8, v8, v35, v36
    v_mfma_f32_32x32x16_bf16 a[48:63], a[156:159], v[68:71], a[48:63]
    v_max3_f32 v8, v8, v37, v38
    v_max3_f32 v8, v8, v39, v40
    v_max3_f32 v8, v8, v41, v42
    buffer_load_dwordx4 v12, s[32:35], s45 offen offset:1024 nt lds
    v_max3_f32 v8, v8, v43, v44
    v_max3_f32 v8, v8, v45, v46
    v_max_f32 v8, v8, v47
    v_cmp_nge_f32 vcc, s52, v8
    s_cbranch_vccz L1_join10
    s_swappc_b64 s[60:61], s[56:57]
L1_join10:
    s_waitcnt lgkmcnt(6)
    v_mfma_f32_32x32x16_bf16 v[48:63], a[96:99], a[64:67], v[80:95]
    ds_read_b64_tr_b16 a[128:129], v22 offset:0
    v_exp_f32 v32, v32
    ds_read_b64_tr_b16 a[130:131], v22 offset:2048
    v_exp_f32 v33, v33
    v_mfma_f32_32x32x16_bf16 v[48:63], a[100:103], a[68:71], v[48:63]
    ds_read_b64_tr_b16 a[132:133], v23 offset:0
    v_exp_f32 v34, v34
    ds_read_b64_tr_b16 a[134:135], v23 offset:2048
    v_add_f32 v6, v6, v32
    s_waitcnt lgkmcnt(8)
    v_mfma_f32_32x32x16_bf16 v[48:63], a[104:107], a[72:75], v[48:63]
    ds_read_b64_tr_b16 a[136:137], v24 offset:0
    v_exp_f32 v35, v35
    ds_read_b64_tr_b16 a[138:139], v24 offset:2048
    v_add_f32 v6, v6, v33
    v_cvt_pk_bf16_f32 v64, v32, v33
    v_mfma_f32_32x32x16_bf16 v[48:63], a[108:111], a[76:79], v[48:63]
    ds_read_b64_tr_b16 a[140:141], v25 offset:0
    v_exp_f32 v36, v36
    ds_read_b64_tr_b16 a[142:143], v25 offset:2048
    v_add_f32 v6, v6, v34
    s_waitcnt lgkmcnt(10)
    v_mfma_f32_32x32x16_bf16 v[48:63], a[112:115], a[80:83], v[48:63]
    ds_read_b64_tr_b16 a[144:145], v22 offset:4096
    v_exp_f32 v37, v37
    ds_read_b64_tr_b16 a[146:147], v22 offset:6144
    v_add_f32 v6, v6, v35
    v_cvt_pk_bf16_f32 v65, v34, v35
    v_mfma_f32_32x32x16_bf16 v[48:63], a[116:119], a[84:87], v[48:63]
    ds_read_b64_tr_b16 a[148:149], v23 offset:4096
    v_exp_f32 v38, v38
    ds_read_b64_tr_b16 a[150:151], v23 offset:6144
    v_add_f32 v6, v6, v36
    s_waitcnt lgkmcnt(12)
    v_mfma_f32_32x32x16_bf16 v[48:63], a[120:123], a[88:91], v[48:63]
    ds_read_b64_tr_b16 a[152:153], v24 offset:4096
    v_exp_f32 v39, v39
    ds_read_b64_tr_b16 a[154:155], v24 offset:6144
    v_add_f32 v6, v6, v37
    v_cvt_pk_bf16_f32 v66, v36, v37
    v_mfma_f32_32x32x16_bf16 v[48:63], a[124:127], a[92:95], v[48:63]
    ds_read_b64_tr_b16 a[156:157], v25 offset:4096
    v_exp_f32 v40, v40
    ds_read_b64_tr_b16 a[158:159], v25 offset:6144
    v_add_f32 v6, v6, v38
    s_waitcnt lgkmcnt(0)
    v_mfma_f32_32x32x16_bf16 a[0:15], a[128:131], v[72:75], a[0:15]
    s_waitcnt vmcnt(4)
    s_barrier
    v_mfma_f32_32x32x16_bf16 a[16:31], a[132:135], v[72:75], a[16:31]
    ds_read_b128 a[96:99], v14 offset:0
    v_exp_f32 v41, v41
    ds_read_b128 a[100:103], v15 offset:0
    v_add_f32 v6, v6, v39
    v_cvt_pk_bf16_f32 v67, v38, v39
    ds_read_b128 a[104:107], v16 offset:0
    v_exp_f32 v42, v42
    v_mfma_f32_32x32x16_bf16 a[32:47], a[136:139], v[72:75], a[32:47]
    ds_read_b128 a[108:111], v17 offset:0
    v_add_f32 v6, v6, v40
    v_exp_f32 v43, v43
    ds_read_b128 a[112:115], v18 offset:0
    ds_read_b128 a[116:119], v19 offset:0
    v_add_f32 v6, v6, v41
    v_mfma_f32_32x32x16_bf16 a[48:63], a[140:143], v[72:75], a[48:63]
    v_cvt_pk_bf16_f32 v68, v40, v41
    ds_read_b128 a[120:123], v20 offset:0
    v_exp_f32 v44, v44
    ds_read_b128 a[124:127], v21 offset:0
    v_add_f32 v6, v6, v42
    v_exp_f32 v45, v45
    v_mfma_f32_32x32x16_bf16 a[0:15], a[144:147], v[76:79], a[0:15]
    s_add_u32 s46, s22, 32768
    s_mov_b32 m0, s46
    s_add_u32 s45, s25, 229376
    s_and_b32 s45, s45, 0x3ffff
    v_add_f32 v6, v6, v43
    v_cvt_pk_bf16_f32 v69, v42, v43
    buffer_load_dwordx4 v10, s[28:31], s45 offen offset:0 nt lds
    v_exp_f32 v46, v46
    v_mfma_f32_32x32x16_bf16 a[16:31], a[148:151], v[76:79], a[16:31]
    v_add_f32 v6, v6, v44
    v_exp_f32 v47, v47
    buffer_load_dwordx4 v11, s[28:31], s45 offen offset:1024 nt lds
    v_add_f32 v6, v6, v45
    v_cvt_pk_bf16_f32 v70, v44, v45
    v_add_f32 v6, v6, v46
    v_mfma_f32_32x32x16_bf16 a[32:47], a[152:155], v[76:79], a[32:47]
    s_add_u32 s46, s22, 49152
    s_mov_b32 m0, s46
    s_add_u32 s45, s25, 196608
    s_and_b32 s45, s45, 0x3ffff
    v_add_f32 v6, v6, v47
    v_cvt_pk_bf16_f32 v71, v46, v47
    v_max3_f32 v8, v48, v49, v50
    buffer_load_dwordx4 v12, s[32:35], s45 offen offset:0 nt lds
    v_max3_f32 v8, v8, v51, v52
    v_mfma_f32_32x32x16_bf16 a[48:63], a[156:159], v[76:79], a[48:63]
    v_max3_f32 v8, v8, v53, v54
    v_max3_f32 v8, v8, v55, v56
    v_max3_f32 v8, v8, v57, v58
    buffer_load_dwordx4 v12, s[32:35], s45 offen offset:1024 nt lds
    v_max3_f32 v8, v8, v59, v60
    v_max3_f32 v8, v8, v61, v62
    v_max_f32 v8, v8, v63
    v_cmp_nge_f32 vcc, s52, v8
    s_cbranch_vccz L1_join11
    s_swappc_b64 s[60:61], s[58:59]
L1_join11:
    s_waitcnt lgkmcnt(6)
    v_mfma_f32_32x32x16_bf16 v[32:47], a[96:99], a[64:67], v[80:95]
    ds_read_b64_tr_b16 a[128:129], v22 offset:16384
    v_exp_f32 v48, v48
    ds_read_b64_tr_b16 a[130:131], v22 offset:18432
    v_exp_f32 v49, v49
    v_mfma_f32_32x32x16_bf16 v[32:47], a[100:103], a[68:71], v[32:47]
    ds_read_b64_tr_b16 a[132:133], v23 offset:16384
    v_exp_f32 v50, v50
    ds_read_b64_tr_b16 a[134:135], v23 offset:18432
    v_add_f32 v6, v6, v48
    s_waitcnt lgkmcnt(8)
    v_mfma_f32_32x32x16_bf16 v[32:47], a[104:107], a[72:75], v[32:47]
    ds_read_b64_tr_b16 a[136:137], v24 offset:16384
    v_exp_f32 v51, v51
    ds_read_b64_tr_b16 a[138:139], v24 offset:18432
    v_add_f32 v6, v6, v49
    v_cvt_pk_bf16_f32 v72, v48, v49
    v_mfma_f32_32x32x16_bf16 v[32:47], a[108:111], a[76:79], v[32:47]
    ds_read_b64_tr_b16 a[140:141], v25 offset:16384
    v_exp_f32 v52, v52
    ds_read_b64_tr_b16 a[142:143], v25 offset:18432
    v_add_f32 v6, v6, v50
    s_waitcnt lgkmcnt(10)
    v_mfma_f32_32x32x16_bf16 v[32:47], a[112:115], a[80:83], v[32:47]
    ds_read_b64_tr_b16 a[144:145], v22 offset:20480
    v_exp_f32 v53, v53
    ds_read_b64_tr_b16 a[146:147], v22 offset:22528
    v_add_f32 v6, v6, v51
    v_cvt_pk_bf16_f32 v73, v50, v51
    v_mfma_f32_32x32x16_bf16 v[32:47], a[116:119], a[84:87], v[32:47]
    ds_read_b64_tr_b16 a[148:149], v23 offset:20480
    v_exp_f32 v54, v54
    ds_read_b64_tr_b16 a[150:151], v23 offset:22528
    v_add_f32 v6, v6, v52
    s_waitcnt lgkmcnt(12)
    v_mfma_f32_32x32x16_bf16 v[32:47], a[120:123], a[88:91], v[32:47]
    ds_read_b64_tr_b16 a[152:153], v24 offset:20480
    v_exp_f32 v55, v55
    ds_read_b64_tr_b16 a[154:155], v24 offset:22528
    v_add_f32 v6, v6, v53
    v_cvt_pk_bf16_f32 v74, v52, v53
    v_mfma_f32_32x32x16_bf16 v[32:47], a[124:127], a[92:95], v[32:47]
    ds_read_b64_tr_b16 a[156:157], v25 offset:20480
    v_exp_f32 v56, v56
    ds_read_b64_tr_b16 a[158:159], v25 offset:22528
    v_add_f32 v6, v6, v54
    s_waitcnt lgkmcnt(0)
    v_mfma_f32_32x32x16_bf16 a[0:15], a[128:131], v[64:67], a[0:15]
    s_waitcnt vmcnt(4)
    s_barrier
    v_mfma_f32_32x32x16_bf16 a[16:31], a[132:135], v[64:67], a[16:31]
    ds_read_b128 a[96:99], v14 offset:16384
    v_exp_f32 v57, v57
    ds_read_b128 a[100:103], v15 offset:16384
    v_add_f32 v6, v6, v55
    v_cvt_pk_bf16_f32 v75, v54, v55
    ds_read_b128 a[104:107], v16 offset:16384
    v_exp_f32 v58, v58
    v_mfma_f32_32x32x16_bf16 a[32:47], a[136:139], v[64:67], a[32:47]
    ds_read_b128 a[108:111], v17 offset:16384
    v_add_f32 v6, v6, v56
    v_exp_f32 v59, v59
    ds_read_b128 a[112:115], v18 offset:16384
    ds_read_b128 a[116:119], v19 offset:16384
    v_add_f32 v6, v6, v57
    v_mfma_f32_32x32x16_bf16 a[48:63], a[140:143], v[64:67], a[48:63]
    v_cvt_pk_bf16_f32 v76, v56, v57
    ds_read_b128 a[120:123], v20 offset:16384
    v_exp_f32 v60, v60
    ds_read_b128 a[124:127], v21 offset:16384
    v_add_f32 v6, v6, v58
    v_exp_f32 v61, v61
    v_mfma_f32_32x32x16_bf16 a[0:15], a[144:147], v[68:71], a[0:15]
    s_add_u32 s46, s22, 0
    s_mov_b32 m0, s46
    s_add_u32 s45, s25, 245760
    s_and_b32 s45, s45, 0x3ffff
    v_add_f32 v6, v6, v59
    v_cvt_pk_bf16_f32 v77, v58, v59
    buffer_load_dwordx4 v10, s[28:31], s45 offen offset:0 nt lds
    v_exp_f32 v62, v62
    v_mfma_f32_32x32x16_bf16 a[16:31], a[148:151], v[68:71], a[16:31]
    v_add_f32 v6, v6, v60
    v_exp_f32 v63, v63
    buffer_load_dwordx4 v11, s[28:31], s45 offen offset:1024 nt lds
    v_add_f32 v6, v6, v61
    v_cvt_pk_bf16_f32 v78, v60, v61
    v_add_f32 v6, v6, v62
    v_mfma_f32_32x32x16_bf16 a[32:47], a[152:155], v[68:71], a[32:47]
    s_add_u32 s46, s22, 65536
    s_mov_b32 m0, s46
    s_add_u32 s45, s25, 212992
    s_and_b32 s45, s45, 0x3ffff
    v_add_f32 v6, v6, v63
    v_cvt_pk_bf16_f32 v79, v62, v63
    v_max3_f32 v8, v32, v33, v34
    buffer_load_dwordx4 v12, s[32:35], s45 offen offset:0 nt lds
    v_max3_f32 v8, v8, v35, v36
    v_mfma_f32_32x32x16_bf16 a[48:63], a[156:159], v[68:71], a[48:63]
    v_max3_f32 v8, v8, v37, v38
    v_max3_f32 v8, v8, v39, v40
    v_max3_f32 v8, v8, v41, v42
    buffer_load_dwordx4 v12, s[32:35], s45 offen offset:1024 nt lds
    v_max3_f32 v8, v8, v43, v44
    v_max3_f32 v8, v8, v45, v46
    v_max_f32 v8, v8, v47
    v_cmp_nge_f32 vcc, s52, v8
    s_cbranch_vccz L1_join12
    s_swappc_b64 s[60:61], s[56:57]
L1_join12:
    s_waitcnt lgkmcnt(6)
    v_mfma_f32_32x32x16_bf16 v[48:63], a[96:99], a[64:67], v[80:95]
    ds_read_b64_tr_b16 a[128:129], v22 offset:32768
    v_exp_f32 v32, v32
    ds_read_b64_tr_b16 a[130:131], v22 offset:34816
    v_exp_f32 v33, v33
    v_mfma_f32_32x32x16_bf16 v[48:63], a[100:103], a[68:71], v[48:63]
    ds_read_b64_tr_b16 a[132:133], v23 offset:32768
    v_exp_f32 v34, v34
    ds_read_b64_tr_b16 a[134:135], v23 offset:34816
    v_add_f32 v6, v6, v32
    s_waitcnt lgkmcnt(8)
    v_mfma_f32_32x32x16_bf16 v[48:63], a[104:107], a[72:75], v[48:63]
    ds_read_b64_tr_b16 a[136:137], v24 offset:32768
    v_exp_f32 v35, v35
    ds_read_b64_tr_b16 a[138:139], v24 offset:34816
    v_add_f32 v6, v6, v33
    v_cvt_pk_bf16_f32 v64, v32, v33
    v_mfma_f32_32x32x16_bf16 v[48:63], a[108:111], a[76:79], v[48:63]
    ds_read_b64_tr_b16 a[140:141], v25 offset:32768
    v_exp_f32 v36, v36
    ds_read_b64_tr_b16 a[142:143], v25 offset:34816
    v_add_f32 v6, v6, v34
    s_waitcnt lgkmcnt(10)
    v_mfma_f32_32x32x16_bf16 v[48:63], a[112:115], a[80:83], v[48:63]
    ds_read_b64_tr_b16 a[144:145], v22 offset:36864
    v_exp_f32 v37, v37
    ds_read_b64_tr_b16 a[146:147], v22 offset:38912
    v_add_f32 v6, v6, v35
    v_cvt_pk_bf16_f32 v65, v34, v35
    v_mfma_f32_32x32x16_bf16 v[48:63], a[116:119], a[84:87], v[48:63]
    ds_read_b64_tr_b16 a[148:149], v23 offset:36864
    v_exp_f32 v38, v38
    ds_read_b64_tr_b16 a[150:151], v23 offset:38912
    v_add_f32 v6, v6, v36
    s_waitcnt lgkmcnt(12)
    v_mfma_f32_32x32x16_bf16 v[48:63], a[120:123], a[88:91], v[48:63]
    ds_read_b64_tr_b16 a[152:153], v24 offset:36864
    v_exp_f32 v39, v39
    ds_read_b64_tr_b16 a[154:155], v24 offset:38912
    v_add_f32 v6, v6, v37
    v_cvt_pk_bf16_f32 v66, v36, v37
    v_mfma_f32_32x32x16_bf16 v[48:63], a[124:127], a[92:95], v[48:63]
    ds_read_b64_tr_b16 a[156:157], v25 offset:36864
    v_exp_f32 v40, v40
    ds_read_b64_tr_b16 a[158:159], v25 offset:38912
    v_add_f32 v6, v6, v38
    s_waitcnt lgkmcnt(0)
    v_mfma_f32_32x32x16_bf16 a[0:15], a[128:131], v[72:75], a[0:15]
    s_waitcnt vmcnt(4)
    s_barrier
    v_mfma_f32_32x32x16_bf16 a[16:31], a[132:135], v[72:75], a[16:31]
    ds_read_b128 a[96:99], v14 offset:32768
    v_exp_f32 v41, v41
    v_add_f32 v6, v6, v39
    ds_read_b128 a[100:103], v15 offset:32768
    v_cvt_pk_bf16_f32 v67, v38, v39
    v_exp_f32 v42, v42
    v_mfma_f32_32x32x16_bf16 a[32:47], a[136:139], v[72:75], a[32:47]
    ds_read_b128 a[104:107], v16 offset:32768
    v_add_f32 v6, v6, v40
    v_exp_f32 v43, v43
    ds_read_b128 a[108:111], v17 offset:32768
    v_add_f32 v6, v6, v41
    v_mfma_f32_32x32x16_bf16 a[48:63], a[140:143], v[72:75], a[48:63]
    v_cvt_pk_bf16_f32 v68, v40, v41
    ds_read_b128 a[112:115], v18 offset:32768
    v_exp_f32 v44, v44
    ds_read_b128 a[116:119], v19 offset:32768
    v_add_f32 v6, v6, v42
    v_exp_f32 v45, v45
    v_mfma_f32_32x32x16_bf16 a[0:15], a[144:147], v[76:79], a[0:15]
    ds_read_b128 a[120:123], v20 offset:32768
    v_add_f32 v6, v6, v43
    v_cvt_pk_bf16_f32 v69, v42, v43
    ds_read_b128 a[124:127], v21 offset:32768
    v_exp_f32 v46, v46
    v_add_f32 v6, v6, v44
    v_mfma_f32_32x32x16_bf16 a[16:31], a[148:151], v[76:79], a[16:31]
    s_add_u32 s46, s22, 81920
    s_mov_b32 m0, s46
    s_add_u32 s45, s25, 229376
    s_and_b32 s45, s45, 0x3ffff
    v_exp_f32 v47, v47
    v_add_f32 v6, v6, v45
    v_cvt_pk_bf16_f32 v70, v44, v45
    v_add_f32 v6, v6, v46
    v_mfma_f32_32x32x16_bf16 a[32:47], a[152:155], v[76:79], a[32:47]
    buffer_load_dwordx4 v12, s[32:35], s45 offen offset:0 nt lds
    v_add_f32 v6, v6, v47
    v_cvt_pk_bf16_f32 v71, v46, v47
    v_max3_f32 v8, v48, v49, v50
    v_max3_f32 v8, v8, v51, v52
    v_max3_f32 v8, v8, v53, v54
    v_mfma_f32_32x32x16_bf16 a[48:63], a[156:159], v[76:79], a[48:63]
    buffer_load_dwordx4 v12, s[32:35], s45 offen offset:1024 nt lds
    v_max3_f32 v8, v8, v55, v56
    v_max3_f32 v8, v8, v57, v58
    v_max3_f32 v8, v8, v59, v60
    v_max3_f32 v8, v8, v61, v62
    v_max_f32 v8, v8, v63
    v_cmp_nge_f32 vcc, s52, v8
    s_cbranch_vccz L1_join13
    s_swappc_b64 s[60:61], s[58:59]
L1_join13:
    s_waitcnt lgkmcnt(6)
    v_mfma_f32_32x32x16_bf16 v[32:47], a[96:99], a[64:67], v[80:95]
    ds_read_b64_tr_b16 a[128:129], v22 offset:0
    v_exp_f32 v48, v48
    ds_read_b64_tr_b16 a[130:131], v22 offset:2048
    v_exp_f32 v49, v49
    v_mfma_f32_32x32x16_bf16 v[32:47], a[100:103], a[68:71], v[32:47]
    ds_read_b64_tr_b16 a[132:133], v23 offset:0
    v_exp_f32 v50, v50
    ds_read_b64_tr_b16 a[134:135], v23 offset:2048
    v_add_f32 v6, v6, v48
    s_waitcnt lgkmcnt(8)
    v_mfma_f32_32x32x16_bf16 v[32:47], a[104:107], a[72:75], v[32:47]
    ds_read_b64_tr_b16 a[136:137], v24 offset:0
    v_exp_f32 v51, v51
    ds_read_b64_tr_b16 a[138:139], v24 offset:2048
    v_add_f32 v6, v6, v49
    v_cvt_pk_bf16_f32 v72, v48, v49
    v_mfma_f32_32x32x16_bf16 v[32:47], a[108:111], a[76:79], v[32:47]
    ds_read_b64_tr_b16 a[140:141], v25 offset:0
    v_exp_f32 v52, v52
    ds_read_b64_tr_b16 a[142:143], v25 offset:2048
    v_add_f32 v6, v6, v50
    s_waitcnt lgkmcnt(10)
    v_mfma_f32_32x32x16_bf16 v[32:47], a[112:115], a[80:83], v[32:47]
    ds_read_b64_tr_b16 a[144:145], v22 offset:4096
    v_exp_f32 v53, v53
    ds_read_b64_tr_b16 a[146:147], v22 offset:6144
    v_add_f32 v6, v6, v51
    v_cvt_pk_bf16_f32 v73, v50, v51
    v_mfma_f32_32x32x16_bf16 v[32:47], a[116:119], a[84:87], v[32:47]
    ds_read_b64_tr_b16 a[148:149], v23 offset:4096
    v_exp_f32 v54, v54
    ds_read_b64_tr_b16 a[150:151], v23 offset:6144
    v_add_f32 v6, v6, v52
    s_waitcnt lgkmcnt(12)
    v_mfma_f32_32x32x16_bf16 v[32:47], a[120:123], a[88:91], v[32:47]
    ds_read_b64_tr_b16 a[152:153], v24 offset:4096
    v_exp_f32 v55, v55
    ds_read_b64_tr_b16 a[154:155], v24 offset:6144
    v_add_f32 v6, v6, v53
    v_cvt_pk_bf16_f32 v74, v52, v53
    v_mfma_f32_32x32x16_bf16 v[32:47], a[124:127], a[92:95], v[32:47]
    ds_read_b64_tr_b16 a[156:157], v25 offset:4096
    v_exp_f32 v56, v56
    ds_read_b64_tr_b16 a[158:159], v25 offset:6144
    v_add_f32 v6, v6, v54
    s_waitcnt lgkmcnt(0)
    v_mfma_f32_32x32x16_bf16 a[0:15], a[128:131], v[64:67], a[0:15]
    s_waitcnt vmcnt(2)
    s_barrier
    v_mfma_f32_32x32x16_bf16 a[16:31], a[132:135], v[64:67], a[16:31]
    ds_read_b128 a[96:99], v14 offset:0
    v_exp_f32 v57, v57
    v_add_f32 v6, v6, v55
    ds_read_b128 a[100:103], v15 offset:0
    v_cvt_pk_bf16_f32 v75, v54, v55
    v_exp_f32 v58, v58
    v_mfma_f32_32x32x16_bf16 a[32:47], a[136:139], v[64:67], a[32:47]
    ds_read_b128 a[104:107], v16 offset:0
    v_add_f32 v6, v6, v56
    ds_read_b128 a[108:111], v17 offset:0
    v_exp_f32 v59, v59
    ds_read_b128 a[112:115], v18 offset:0
    v_add_f32 v6, v6, v57
    v_mfma_f32_32x32x16_bf16 a[48:63], a[140:143], v[64:67], a[48:63]
    v_cvt_pk_bf16_f32 v76, v56, v57
    ds_read_b128 a[116:119], v19 offset:0
    v_exp_f32 v60, v60
    ds_read_b128 a[120:123], v20 offset:0
    v_add_f32 v6, v6, v58
    v_exp_f32 v61, v61
    v_mfma_f32_32x32x16_bf16 a[0:15], a[144:147], v[68:71], a[0:15]
    ds_read_b128 a[124:127], v21 offset:0
    v_add_f32 v6, v6, v59
    s_add_u32 s46, s22, 49152
    s_mov_b32 m0, s46
    s_add_u32 s45, s25, 245760
    s_and_b32 s45, s45, 0x3ffff
    v_cvt_pk_bf16_f32 v77, v58, v59
    v_exp_f32 v62, v62
    v_mfma_f32_32x32x16_bf16 a[16:31], a[148:151], v[68:71], a[16:31]
    v_add_f32 v6, v6, v60
    v_exp_f32 v63, v63
    buffer_load_dwordx4 v12, s[32:35], s45 offen offset:0 nt lds
    v_add_f32 v6, v6, v61
    v_cvt_pk_bf16_f32 v78, v60, v61
    v_add_f32 v6, v6, v62
    v_mfma_f32_32x32x16_bf16 a[32:47], a[152:155], v[68:71], a[32:47]
    buffer_load_dwordx4 v12, s[32:35], s45 offen offset:1024 nt lds
    v_add_f32 v6, v6, v63
    v_cvt_pk_bf16_f32 v79, v62, v63
    v_max3_f32 v8, v32, v33, v34
    v_max3_f32 v8, v8, v35, v36
    v_mfma_f32_32x32x16_bf16 a[48:63], a[156:159], v[68:71], a[48:63]
    s_bitcmp1_b32 s2, 0
    s_cbranch_scc1 L1_nowt
    s_lshl_b32 s44, s40, 13
    s_lshl_b32 s45, s2, 15
    s_add_u32 s54, s44, s45
    s_mov_b32 s48, s26
    s_and_b32 s49, s27, 0xffff
    s_mov_b32 s50, 0x800000
    s_mov_b32 s51, 0x20000
    buffer_load_dword v30, v13, s[48:51], s54 offen
L1_nowt:
    v_max3_f32 v8, v8, v37, v38
    v_max3_f32 v8, v8, v39, v40
    v_max3_f32 v8, v8, v41, v42
    v_max3_f32 v8, v8, v43, v44
    v_max3_f32 v8, v8, v45, v46
    v_max_f32 v8, v8, v47
    v_cmp_nge_f32 vcc, s52, v8
    s_cbranch_vccz L1_join14
    s_swappc_b64 s[60:61], s[56:57]
L1_join14:
    s_waitcnt lgkmcnt(6)
    v_mfma_f32_32x32x16_bf16 v[48:63], a[96:99], a[64:67], v[80:95]
    ds_read_b64_tr_b16 a[128:129], v22 offset:16384
    v_exp_f32 v32, v32
    ds_read_b64_tr_b16 a[130:131], v22 offset:18432
    v_exp_f32 v33, v33
    v_mfma_f32_32x32x16_bf16 v[48:63], a[100:103], a[68:71], v[48:63]
    ds_read_b64_tr_b16 a[132:133], v23 offset:16384
    v_exp_f32 v34, v34
    ds_read_b64_tr_b16 a[134:135], v23 offset:18432
    v_add_f32 v6, v6, v32
    s_waitcnt lgkmcnt(8)
    v_mfma_f32_32x32x16_bf16 v[48:63], a[104:107], a[72:75], v[48:63]
    ds_read_b64_tr_b16 a[136:137], v24 offset:16384
    v_exp_f32 v35, v35
    ds_read_b64_tr_b16 a[138:139], v24 offset:18432
    v_add_f32 v6, v6, v33
    v_cvt_pk_bf16_f32 v64, v32, v33
    v_mfma_f32_32x32x16_bf16 v[48:63], a[108:111], a[76:79], v[48:63]
    ds_read_b64_tr_b16 a[140:141], v25 offset:16384
    v_exp_f32 v36, v36
    ds_read_b64_tr_b16 a[142:143], v25 offset:18432
    v_add_f32 v6, v6, v34
    s_waitcnt lgkmcnt(10)
    v_mfma_f32_32x32x16_bf16 v[48:63], a[112:115], a[80:83], v[48:63]
    ds_read_b64_tr_b16 a[144:145], v22 offset:20480
    v_exp_f32 v37, v37
    ds_read_b64_tr_b16 a[146:147], v22 offset:22528
    v_add_f32 v6, v6, v35
    v_cvt_pk_bf16_f32 v65, v34, v35
    v_mfma_f32_32x32x16_bf16 v[48:63], a[116:119], a[84:87], v[48:63]
    ds_read_b64_tr_b16 a[148:149], v23 offset:20480
    v_exp_f32 v38, v38
    ds_read_b64_tr_b16 a[150:151], v23 offset:22528
    v_add_f32 v6, v6, v36
    s_waitcnt lgkmcnt(12)
    v_mfma_f32_32x32x16_bf16 v[48:63], a[120:123], a[88:91], v[48:63]
    ds_read_b64_tr_b16 a[152:153], v24 offset:20480
    v_exp_f32 v39, v39
    ds_read_b64_tr_b16 a[154:155], v24 offset:22528
    v_add_f32 v6, v6, v37
    v_cvt_pk_bf16_f32 v66, v36, v37
    v_mfma_f32_32x32x16_bf16 v[48:63], a[124:127], a[92:95], v[48:63]
    ds_read_b64_tr_b16 a[156:157], v25 offset:20480
    v_exp_f32 v40, v40
    ds_read_b64_tr_b16 a[158:159], v25 offset:22528
    v_add_f32 v6, v6, v38
    s_waitcnt lgkmcnt(0)
    v_mfma_f32_32x32x16_bf16 a[0:15], a[128:131], v[72:75], a[0:15]
    s_waitcnt vmcnt(2)
    s_barrier
    v_mfma_f32_32x32x16_bf16 a[16:31], a[132:135], v[72:75], a[16:31]
    v_exp_f32 v41, v41
    v_add_f32 v6, v6, v39
    v_cvt_pk_bf16_f32 v67, v38, v39
    v_exp_f32 v42, v42
    v_mfma_f32_32x32x16_bf16 a[32:47], a[136:139], v[72:75], a[32:47]
    v_add_f32 v6, v6, v40
    v_exp_f32 v43, v43
    v_add_f32 v6, v6, v41
    v_mfma_f32_32x32x16_bf16 a[48:63], a[140:143], v[72:75], a[48:63]
    v_cvt_pk_bf16_f32 v68, v40, v41
    v_exp_f32 v44, v44
    v_add_f32 v6, v6, v42
    v_exp_f32 v45, v45
    v_mfma_f32_32x32x16_bf16 a[0:15], a[144:147], v[76:79], a[0:15]
    v_add_f32 v6, v6, v43
    v_cvt_pk_bf16_f32 v69, v42, v43
    v_exp_f32 v46, v46
    v_add_f32 v6, v6, v44
    v_mfma_f32_32x32x16_bf16 a[16:31], a[148:151], v[76:79], a[16:31]
    v_exp_f32 v47, v47
    v_add_f32 v6, v6, v45
    v_cvt_pk_bf16_f32 v70, v44, v45
    v_add_f32 v6, v6, v46
    v_mfma_f32_32x32x16_bf16 a[32:47], a[152:155], v[76:79], a[32:47]
    v_add_f32 v6, v6, v47
    v_cvt_pk_bf16_f32 v71, v46, v47
    v_max3_f32 v8, v48, v49, v50
    v_max3_f32 v8, v8, v51, v52
    v_max3_f32 v8, v8, v53, v54
    v_mfma_f32_32x32x16_bf16 a[48:63], a[156:159], v[76:79], a[48:63]
    v_max3_f32 v8, v8, v55, v56
    v_max3_f32 v8, v8, v57, v58
    v_max3_f32 v8, v8, v59, v60
    v_max3_f32 v8, v8, v61, v62
    v_max_f32 v8, v8, v63
    v_cmp_nge_f32 vcc, s52, v8
    s_cbranch_vccz L1_join15
    s_swappc_b64 s[60:61], s[58:59]
L1_join15:
    ds_read_b64_tr_b16 a[128:129], v22 offset:32768
    v_exp_f32 v48, v48
    ds_read_b64_tr_b16 a[130:131], v22 offset:34816
    v_exp_f32 v49, v49
    ds_read_b64_tr_b16 a[132:133], v23 offset:32768
    v_exp_f32 v50, v50
    ds_read_b64_tr_b16 a[134:135], v23 offset:34816
    v_add_f32 v6, v6, v48
    ds_read_b64_tr_b16 a[136:137], v24 offset:32768
    v_exp_f32 v51, v51
    ds_read_b64_tr_b16 a[138:139], v24 offset:34816
    v_add_f32 v6, v6, v49
    v_cvt_pk_bf16_f32 v72, v48, v49
    ds_read_b64_tr_b16 a[140:141], v25 offset:32768
    v_exp_f32 v52, v52
    ds_read_b64_tr_b16 a[142:143], v25 offset:34816
    v_add_f32 v6, v6, v50
    ds_read_b64_tr_b16 a[144:145], v22 offset:36864
    v_exp_f32 v53, v53
    ds_read_b64_tr_b16 a[146:147], v22 offset:38912
    v_add_f32 v6, v6, v51
    v_cvt_pk_bf16_f32 v73, v50, v51
    ds_read_b64_tr_b16 a[148:149], v23 offset:36864
    v_exp_f32 v54, v54
    ds_read_b64_tr_b16 a[150:151], v23 offset:38912
    v_add_f32 v6, v6, v52
    ds_read_b64_tr_b16 a[152:153], v24 offset:36864
    v_exp_f32 v55, v55
    ds_read_b64_tr_b16 a[154:155], v24 offset:38912
    v_add_f32 v6, v6, v53
    v_cvt_pk_bf16_f32 v74, v52, v53
    ds_read_b64_tr_b16 a[156:157], v25 offset:36864
    v_exp_f32 v56, v56
    ds_read_b64_tr_b16 a[158:159], v25 offset:38912
    v_add_f32 v6, v6, v54
    s_waitcnt lgkmcnt(0)
    v_mfma_f32_32x32x16_bf16 a[0:15], a[128:131], v[64:67], a[0:15]
    s_waitcnt vmcnt(0)
    s_barrier
    v_mfma_f32_32x32x16_bf16 a[16:31], a[132:135], v[64:67], a[16:31]
    v_exp_f32 v57, v57
    v_add_f32 v6, v6, v55
    v_cvt_pk_bf16_f32 v75, v54, v55
    v_mfma_f32_32x32x16_bf16 a[32:47], a[136:139], v[64:67], a[32:47]
    v_exp_f32 v58, v58
    v_add_f32 v6, v6, v56
    v_exp_f32 v59, v59
    v_mfma_f32_32x32x16_bf16 a[48:63], a[140:143], v[64:67], a[48:63]
    v_add_f32 v6, v6, v57
    v_cvt_pk_bf16_f32 v76, v56, v57
    v_exp_f32 v60, v60
    v_mfma_f32_32x32x16_bf16 a[0:15], a[144:147], v[68:71], a[0:15]
    v_add_f32 v6, v6, v58
    v_exp_f32 v61, v61
    v_mfma_f32_32x32x16_bf16 a[16:31], a[148:151], v[68:71], a[16:31]
    v_add_f32 v6, v6, v59
    v_cvt_pk_bf16_f32 v77, v58, v59
    v_exp_f32 v62, v62
    v_mfma_f32_32x32x16_bf16 a[32:47], a[152:155], v[68:71], a[32:47]
    v_add_f32 v6, v6, v60
    v_exp_f32 v63, v63
    v_add_f32 v6, v6, v61
    v_mfma_f32_32x32x16_bf16 a[48:63], a[156:159], v[68:71], a[48:63]
    v_cvt_pk_bf16_f32 v78, v60, v61
    v_add_f32 v6, v6, v62
    v_add_f32 v6, v6, v63
    v_cvt_pk_bf16_f32 v79, v62, v63
    ds_read_b64_tr_b16 a[128:129], v22 offset:0
    ds_read_b64_tr_b16 a[130:131], v22 offset:2048
    ds_read_b64_tr_b16 a[132:133], v23 offset:0
    ds_read_b64_tr_b16 a[134:135], v23 offset:2048
    ds_read_b64_tr_b16 a[136:137], v24 offset:0
    ds_read_b64_tr_b16 a[138:139], v24 offset:2048
    ds_read_b64_tr_b16 a[140:141], v25 offset:0
    ds_read_b64_tr_b16 a[142:143], v25 offset:2048
    ds_read_b64_tr_b16 a[144:145], v22 offset:4096
    ds_read_b64_tr_b16 a[146:147], v22 offset:6144
    ds_read_b64_tr_b16 a[148:149], v23 offset:4096
    ds_read_b64_tr_b16 a[150:151], v23 offset:6144
    ds_read_b64_tr_b16 a[152:153], v24 offset:4096
    ds_read_b64_tr_b16 a[154:155], v24 offset:6144
    ds_read_b64_tr_b16 a[156:157], v25 offset:4096
    ds_read_b64_tr_b16 a[158:159], v25 offset:6144
    s_waitcnt lgkmcnt(12)
    v_mfma_f32_32x32x16_bf16 a[0:15], a[128:131], v[72:75], a[0:15]
    v_mfma_f32_32x32x16_bf16 a[16:31], a[132:135], v[72:75], a[16:31]
    s_waitcnt lgkmcnt(8)
    v_mfma_f32_32x32x16_bf16 a[32:47], a[136:139], v[72:75], a[32:47]
    v_mfma_f32_32x32x16_bf16 a[48:63], a[140:143], v[72:75], a[48:63]
    s_waitcnt lgkmcnt(4)
    v_mfma_f32_32x32x16_bf16 a[0:15], a[144:147], v[76:79], a[0:15]
    v_mfma_f32_32x32x16_bf16 a[16:31], a[148:151], v[76:79], a[16:31]
    s_waitcnt lgkmcnt(0)
    v_mfma_f32_32x32x16_bf16 a[32:47], a[152:155], v[76:79], a[32:47]
    v_mfma_f32_32x32x16_bf16 a[48:63], a[156:159], v[76:79], a[48:63]
    v_mov_b32 v2, v6
    s_lshl_b32 s44, s40, 13
    s_add_u32 s44, s44, 98304
    v_permlane32_swap_b32 v6, v2
    s_xor_b32 s45, s40, 4
    s_lshl_b32 s45, s45, 13
    s_add_u32 s45, s45, 98304
    v_add_f32 v6, v6, v2
    v_mov_b32 v7, v80
    v_add_u32 v3, s44, v31
    v_add_u32 v4, s45, v31
    v_lshlrev_b32 v2, 3, v1
    s_lshl_b32 s44, s40, 9
    s_xor_b32 s45, s44, 2048
    v_add_u32 v5, s44, v2
    v_add_u32 v2, s45, v2
    ds_write_b64 v5, v[6:7]
    s_nop 7
    s_cmp_eq_u32 s21, 1
    s_cbranch_scc1 L1_e1
    ds_write_b128 v3, a[32:35] offset:0
    ds_write_b128 v3, a[36:39] offset:1024
    ds_write_b128 v3, a[40:43] offset:2048
    ds_write_b128 v3, a[44:47] offset:3072
    ds_write_b128 v3, a[48:51] offset:4096
    ds_write_b128 v3, a[52:55] offset:5120
    ds_write_b128 v3, a[56:59] offset:6144
    ds_write_b128 v3, a[60:63] offset:7168
    v_accvgpr_read_b32 v64, a0
    v_accvgpr_read_b32 v65, a1
    v_accvgpr_read_b32 v66, a2
    v_accvgpr_read_b32 v67, a3
    v_accvgpr_read_b32 v68, a4
    v_accvgpr_read_b32 v69, a5
    v_accvgpr_read_b32 v70, a6
    v_accvgpr_read_b32 v71, a7
    v_accvgpr_read_b32 v72, a8
    v_accvgpr_read_b32 v73, a9
    v_accvgpr_read_b32 v74, a10
    v_accvgpr_read_b32 v75, a11
    v_accvgpr_read_b32 v76, a12
    v_accvgpr_read_b32 v77, a13
    v_accvgpr_read_b32 v78, a14
    v_accvgpr_read_b32 v79, a15
    v_accvgpr_read_b32 v80, a16
    v_accvgpr_read_b32 v81, a17
    v_accvgpr_read_b32 v82, a18
    v_accvgpr_read_b32 v83, a19
    v_accvgpr_read_b32 v84, a20
    v_accvgpr_read_b32 v85, a21
    v_accvgpr_read_b32 v86, a22
    v_accvgpr_read_b32 v87, a23
    v_accvgpr_read_b32 v88, a24
    v_accvgpr_read_b32 v89, a25
    v_accvgpr_read_b32 v90, a26
    v_accvgpr_read_b32 v91, a27
    v_accvgpr_read_b32 v92, a28
    v_accvgpr_read_b32 v93, a29
    v_accvgpr_read_b32 v94, a30
    v_accvgpr_read_b32 v95, a31
    s_branch L1_e2
L1_e1:
    ds_write_b128 v3, a[0:3] offset:0
    ds_write_b128 v3, a[4:7] offset:1024
    ds_write_b128 v3, a[8:11] offset:2048
    ds_write_b128 v3, a[12:15] offset:3072
    ds_write_b128 v3, a[16:19] offset:4096
    ds_write_b128 v3, a[20:23] offset:5120
    ds_write_b128 v3, a[24:27] offset:6144
    ds_write_b128 v3, a[28:31] offset:7168
    v_accvgpr_read_b32 v64, a32
    v_accvgpr_read_b32 v65, a33
    v_accvgpr_read_b32 v66, a34
    v_accvgpr_read_b32 v67, a35
    v_accvgpr_read_b32 v68, a36
    v_accvgpr_read_b32 v69, a37
    v_accvgpr_read_b32 v70, a38
    v_accvgpr_read_b32 v71, a39
    v_accvgpr_read_b32 v72, a40
    v_accvgpr_read_b32 v73, a41
    v_accvgpr_read_b32 v74, a42
    v_accvgpr_read_b32 v75, a43
    v_accvgpr_read_b32 v76, a44
    v_accvgpr_read_b32 v77, a45
    v_accvgpr_read_b32 v78, a46
    v_accvgpr_read_b32 v79, a47
    v_accvgpr_read_b32 v80, a48
    v_accvgpr_read_b32 v81, a49
    v_accvgpr_read_b32 v82, a50
    v_accvgpr_read_b32 v83, a51
    v_accvgpr_read_b32 v84, a52
    v_accvgpr_read_b32 v85, a53
    v_accvgpr_read_b32 v86, a54
    v_accvgpr_read_b32 v87, a55
    v_accvgpr_read_b32 v88, a56
    v_accvgpr_read_b32 v89, a57
    v_accvgpr_read_b32 v90, a58
    v_accvgpr_read_b32 v91, a59
    v_accvgpr_read_b32 v92, a60
    v_accvgpr_read_b32 v93, a61
    v_accvgpr_read_b32 v94, a62
    v_accvgpr_read_b32 v95, a63
L1_e2:
    s_waitcnt lgkmcnt(0)
    s_barrier
    ds_read_b64 v[10:11], v2
    ds_read_b128 v[32:35], v4 offset:0
    ds_read_b128 v[36:39], v4 offset:1024
    ds_read_b128 v[40:43], v4 offset:2048
    ds_read_b128 v[44:47], v4 offset:3072
    ds_read_b128 v[48:51], v4 offset:4096
    ds_read_b128 v[52:55], v4 offset:5120
    ds_read_b128 v[56:59], v4 offset:6144
    ds_read_b128 v[60:63], v4 offset:7168
    s_waitcnt lgkmcnt(8)
    v_min_f32 v2, v7, v11
    v_sub_f32 v7, v2, v7
    v_sub_f32 v11, v2, v11
    v_exp_f32 v7, v7
    v_exp_f32 v11, v11
    s_nop 0
    v_mul_f32 v6, v6, v7
    v_fmac_f32 v6, v10, v11
    v_rcp_f32 v6, v6
    s_nop 0
    v_mul_f32 v7, v6, v7
    v_mul_f32 v11, v6, v11
    v_mul_f32 v64, v7, v64
    v_mul_f32 v65, v7, v65
    v_mul_f32 v66, v7, v66
    v_mul_f32 v67, v7, v67
    v_mul_f32 v68, v7, v68
    v_mul_f32 v69, v7, v69
    v_mul_f32 v70, v7, v70
    v_mul_f32 v71, v7, v71
    s_waitcnt lgkmcnt(6)
    v_fmac_f32 v64, v11, v32
    v_fmac_f32 v65, v11, v33
    v_fmac_f32 v66, v11, v34
    v_fmac_f32 v67, v11, v35
    v_fmac_f32 v68, v11, v36
    v_fmac_f32 v69, v11, v37
    v_fmac_f32 v70, v11, v38
    v_fmac_f32 v71, v11, v39
    v_cvt_pk_bf16_f32 v14, v64, v65
    v_cvt_pk_bf16_f32 v15, v66, v67
    v_cvt_pk_bf16_f32 v16, v68, v69
    v_cvt_pk_bf16_f32 v17, v70, v71
    buffer_store_dwordx4 v[14:17], v9, s[36:39], 0 offen offset:0 sc0 sc1
    v_mul_f32 v72, v7, v72
    v_mul_f32 v73, v7, v73
    v_mul_f32 v74, v7, v74
    v_mul_f32 v75, v7, v75
    v_mul_f32 v76, v7, v76
    v_mul_f32 v77, v7, v77
    v_mul_f32 v78, v7, v78
    v_mul_f32 v79, v7, v79
    s_waitcnt lgkmcnt(4)
    v_fmac_f32 v72, v11, v40
    v_fmac_f32 v73, v11, v41
    v_fmac_f32 v74, v11, v42
    v_fmac_f32 v75, v11, v43
    v_fmac_f32 v76, v11, v44
    v_fmac_f32 v77, v11, v45
    v_fmac_f32 v78, v11, v46
    v_fmac_f32 v79, v11, v47
    v_cvt_pk_bf16_f32 v18, v72, v73
    v_cvt_pk_bf16_f32 v19, v74, v75
    v_cvt_pk_bf16_f32 v20, v76, v77
    v_cvt_pk_bf16_f32 v21, v78, v79
    buffer_store_dwordx4 v[18:21], v9, s[36:39], 0 offen offset:1024 sc0 sc1
    v_mul_f32 v80, v7, v80
    v_mul_f32 v81, v7, v81
    v_mul_f32 v82, v7, v82
    v_mul_f32 v83, v7, v83
    v_mul_f32 v84, v7, v84
    v_mul_f32 v85, v7, v85
    v_mul_f32 v86, v7, v86
    v_mul_f32 v87, v7, v87
    s_waitcnt lgkmcnt(2)
    v_fmac_f32 v80, v11, v48
    v_fmac_f32 v81, v11, v49
    v_fmac_f32 v82, v11, v50
    v_fmac_f32 v83, v11, v51
    v_fmac_f32 v84, v11, v52
    v_fmac_f32 v85, v11, v53
    v_fmac_f32 v86, v11, v54
    v_fmac_f32 v87, v11, v55
    v_cvt_pk_bf16_f32 v14, v80, v81
    v_cvt_pk_bf16_f32 v15, v82, v83
    v_cvt_pk_bf16_f32 v16, v84, v85
    v_cvt_pk_bf16_f32 v17, v86, v87
    buffer_store_dwordx4 v[14:17], v9, s[36:39], 0 offen offset:2048 sc0 sc1
    v_mul_f32 v88, v7, v88
    v_mul_f32 v89, v7, v89
    v_mul_f32 v90, v7, v90
    v_mul_f32 v91, v7, v91
    v_mul_f32 v92, v7, v92
    v_mul_f32 v93, v7, v93
    v_mul_f32 v94, v7, v94
    v_mul_f32 v95, v7, v95
    s_waitcnt lgkmcnt(0)
    v_fmac_f32 v88, v11, v56
    v_fmac_f32 v89, v11, v57
    v_fmac_f32 v90, v11, v58
    v_fmac_f32 v91, v11, v59
    v_fmac_f32 v92, v11, v60
    v_fmac_f32 v93, v11, v61
    v_fmac_f32 v94, v11, v62
    v_fmac_f32 v95, v11, v63
    v_cvt_pk_bf16_f32 v18, v88, v89
    v_cvt_pk_bf16_f32 v19, v90, v91
    v_cvt_pk_bf16_f32 v20, v92, v93
    v_cvt_pk_bf16_f32 v21, v94, v95
    buffer_store_dwordx4 v[18:21], v9, s[36:39], 0 offen offset:3072 sc0 sc1
    s_load_dwordx4 s[48:51], s[0:1], 40
    s_bfe_u32 s16, s42, 0x10002
    s_lshr_b32 s44, s42, 3
    s_lshl_b32 s44, s44, 2
    s_and_b32 s45, s42, 3
    s_add_u32 s17, s44, s45
    s_lshl_b32 s22, s40, 14
    s_lshl_b32 s23, s40, 15
    s_lshl_b32 s24, s40, 20
    v_lshrrev_b32 v2, 3, v1
    v_and_b32 v3, 7, v1
    v_bfe_u32 v4, v1, 4, 1
    v_lshlrev_b32 v4, 2, v4
    v_xor_b32 v3, v3, v4
    v_lshlrev_b32 v3, 4, v3
    v_lshl_or_b32 v13, v2, 11, v3
    s_lshl_b32 s45, s17, 7
    s_add_u32 s32, s26, s45
    s_addc_u32 s33, s27, 0
    s_and_b32 s33, s33, 0xffff
    s_sub_u32 s34, 0x800000, s45
    s_mov_b32 s35, 0x20000
    s_waitcnt vmcnt(0) lgkmcnt(0)
    s_barrier
    v_mov_b32 v8, v13
    s_lshl_b32 s44, s41, 5
    s_add_u32 s50, s50, s44
    s_addc_u32 s51, s51, 0
    s_cmp_lg_u32 s40, 0
    s_cbranch_scc1 L1_nosig
    v_mov_b32 v2, 0
    v_mov_b32 v3, 1
    s_mov_b64 exec, 1
    global_atomic_add v2, v3, s[50:51] sc1
    s_mov_b64 exec, -1
    s_waitcnt vmcnt(0)
L1_nosig:
    s_lshl_b32 s46, s41, 1
    s_add_u32 s46, s46, s16
    s_lshl_b32 s44, s46, 19
    s_add_u32 s28, s18, s44
    s_addc_u32 s29, s19, 0
    s_and_b32 s29, s29, 0xffff
    s_mov_b32 s30, 0x80000
    s_mov_b32 s31, 0x20000
    s_add_u32 s46, s22, 0
    s_mov_b32 m0, s46
    s_add_u32 s45, s24, 0
    buffer_load_dwordx4 v8, s[32:35], s45 offen lds
    s_add_u32 s45, s45, 15360
    buffer_load_dwordx4 v8, s[32:35], s45 offen offset:1024 lds
    s_add_u32 s46, s22, 2048
    s_mov_b32 m0, s46
    s_add_u32 s45, s24, 32768
    buffer_load_dwordx4 v8, s[32:35], s45 offen lds
    s_add_u32 s45, s45, 15360
    buffer_load_dwordx4 v8, s[32:35], s45 offen offset:1024 lds
    s_add_u32 s46, s22, 4096
    s_mov_b32 m0, s46
    s_add_u32 s45, s24, 65536
    buffer_load_dwordx4 v8, s[32:35], s45 offen lds
    s_add_u32 s45, s45, 15360
    buffer_load_dwordx4 v8, s[32:35], s45 offen offset:1024 lds
    s_add_u32 s46, s22, 6144
    s_mov_b32 m0, s46
    s_add_u32 s45, s24, 98304
    buffer_load_dwordx4 v8, s[32:35], s45 offen lds
    s_add_u32 s45, s45, 15360
    buffer_load_dwordx4 v8, s[32:35], s45 offen offset:1024 lds
    s_add_u32 s46, s22, 8192
    s_mov_b32 m0, s46
    s_add_u32 s45, s24, 131072
    buffer_load_dwordx4 v8, s[32:35], s45 offen lds
    s_add_u32 s45, s45, 15360
    buffer_load_dwordx4 v8, s[32:35], s45 offen offset:1024 lds
    s_add_u32 s46, s22, 10240
    s_mov_b32 m0, s46
    s_add_u32 s45, s24, 163840
    buffer_load_dwordx4 v8, s[32:35], s45 offen lds
    s_add_u32 s45, s45, 15360
    buffer_load_dwordx4 v8, s[32:35], s45 offen offset:1024 lds
    s_add_u32 s46, s22, 12288
    s_mov_b32 m0, s46
    s_add_u32 s45, s24, 196608
    buffer_load_dwordx4 v8, s[32:35], s45 offen lds
    s_add_u32 s45, s45, 15360
    buffer_load_dwordx4 v8, s[32:35], s45 offen offset:1024 lds
    s_add_u32 s46, s22, 14336
    s_mov_b32 m0, s46
    s_add_u32 s45, s24, 229376
    buffer_load_dwordx4 v8, s[32:35], s45 offen lds
    s_add_u32 s45, s45, 15360
    buffer_load_dwordx4 v8, s[32:35], s45 offen offset:1024 lds
    v_lshlrev_b32 v6, 4, v1
    v_add_u32 v7, 0x40000, v6
    v_lshrrev_b32 v2, 5, v1
    v_bfe_u32 v3, v1, 2, 2
    v_bfe_u32 v4, v1, 4, 1
    v_lshlrev_b32 v4, 5, v4
    v_and_b32 v5, 1, v1
    v_lshl_or_b32 v4, v5, 4, v4
    v_bfe_u32 v5, v1, 1, 1
    v_lshl_or_b32 v4, v5, 3, v4
    v_lshl_or_b32 v4, v3, 7, v4
    v_lshl_or_b32 v4, v2, 10, v4
    v_bfe_u32 v5, v1, 3, 1
    v_lshl_or_b32 v4, v5, 6, v4
    v_add_u32 v9, s22, v4
    v_xor_b32 v10, 64, v9
    v_and_b32 v3, 31, v1
    s_bfe_u32 s47, s40, 0x10001
    s_lshl_b32 s47, s47, 5
    v_add_u32 v3, s47, v3
    v_lshlrev_b32 v3, 11, v3
    v_lshl_or_b32 v12, v2, 4, v3
    s_lshr_b32 s47, s40, 2
    s_lshl_b32 s47, s47, 6
    s_and_b32 s53, s40, 1
    s_lshl_b32 s53, s53, 5
    s_add_u32 s47, s47, s53
    v_add_u32 v12, s47, v12
    v_lshlrev_b32 v11, 4, v1
    s_lshl_b32 s47, s41, 1
    s_add_u32 s47, s47, s16
    s_lshl_b32 s47, s47, 17
    s_lshl_b32 s53, s17, 7
    s_add_u32 s47, s47, s53
    s_add_u32 s36, s48, s47
    s_addc_u32 s37, s49, 0
    s_and_b32 s37, s37, 0xffff
    s_sub_u32 s38, 0x200000, s47
    s_mov_b32 s39, 0x20000
    s_waitcnt vmcnt(14)
    ds_read_b64_tr_b16 a[128:129], v9 offset:0
    ds_read_b64_tr_b16 a[130:131], v9 offset:512
    ds_read_b64_tr_b16 a[132:133], v10 offset:0
    ds_read_b64_tr_b16 a[134:135], v10 offset:512
    s_waitcnt vmcnt(12)
    ds_read_b64_tr_b16 a[136:137], v9 offset:2048
    ds_read_b64_tr_b16 a[138:139], v9 offset:2560
    ds_read_b64_tr_b16 a[140:141], v10 offset:2048
    ds_read_b64_tr_b16 a[142:143], v10 offset:2560
    s_waitcnt lgkmcnt(4)
    s_add_u32 s46, s22, 0
    s_mov_b32 m0, s46
    s_add_u32 s45, s24, 262144
    buffer_load_dwordx4 v8, s[32:35], s45 offen lds
    s_add_u32 s45, s45, 15360
    buffer_load_dwordx4 v8, s[32:35], s45 offen offset:1024 lds
    s_waitcnt vmcnt(12)
    ds_read_b64_tr_b16 a[144:145], v9 offset:4096
    ds_read_b64_tr_b16 a[146:147], v9 offset:4608
    ds_read_b64_tr_b16 a[148:149], v10 offset:4096
    ds_read_b64_tr_b16 a[150:151], v10 offset:4608
    s_waitcnt lgkmcnt(4)
    s_add_u32 s46, s22, 2048
    s_mov_b32 m0, s46
    s_add_u32 s45, s24, 294912
    buffer_load_dwordx4 v8, s[32:35], s45 offen lds
    s_add_u32 s45, s45, 15360
    buffer_load_dwordx4 v8, s[32:35], s45 offen offset:1024 lds
    s_waitcnt vmcnt(12)
    ds_read_b64_tr_b16 a[152:153], v9 offset:6144
    ds_read_b64_tr_b16 a[154:155], v9 offset:6656
    ds_read_b64_tr_b16 a[156:157], v10 offset:6144
    ds_read_b64_tr_b16 a[158:159], v10 offset:6656
    s_waitcnt lgkmcnt(4)
    s_add_u32 s46, s22, 4096
    s_mov_b32 m0, s46
    s_add_u32 s45, s24, 327680
    buffer_load_dwordx4 v8, s[32:35], s45 offen lds
    s_add_u32 s45, s45, 15360
    buffer_load_dwordx4 v8, s[32:35], s45 offen offset:1024 lds
    s_waitcnt vmcnt(12)
    ds_read_b64_tr_b16 v[32:33], v9 offset:8192
    ds_read_b64_tr_b16 v[34:35], v9 offset:8704
    ds_read_b64_tr_b16 v[36:37], v10 offset:8192
    ds_read_b64_tr_b16 v[38:39], v10 offset:8704
    s_waitcnt lgkmcnt(4)
    s_add_u32 s46, s22, 6144
    s_mov_b32 m0, s46
    s_add_u32 s45, s24, 360448
    buffer_load_dwordx4 v8, s[32:35], s45 offen lds
    s_add_u32 s45, s45, 15360
    buffer_load_dwordx4 v8, s[32:35], s45 offen offset:1024 lds
    s_waitcnt vmcnt(12)
    ds_read_b64_tr_b16 v[40:41], v9 offset:10240
    ds_read_b64_tr_b16 v[42:43], v9 offset:10752
    ds_read_b64_tr_b16 v[44:45], v10 offset:10240
    ds_read_b64_tr_b16 v[46:47], v10 offset:10752
    s_waitcnt lgkmcnt(4)
    s_add_u32 s46, s22, 8192
    s_mov_b32 m0, s46
    s_add_u32 s45, s24, 393216
    buffer_load_dwordx4 v8, s[32:35], s45 offen lds
    s_add_u32 s45, s45, 15360
    buffer_load_dwordx4 v8, s[32:35], s45 offen offset:1024 lds
    s_waitcnt vmcnt(12)
    ds_read_b64_tr_b16 v[48:49], v9 offset:12288
    ds_read_b64_tr_b16 v[50:51], v9 offset:12800
    ds_read_b64_tr_b16 v[52:53], v10 offset:12288
    ds_read_b64_tr_b16 v[54:55], v10 offset:12800
    s_waitcnt lgkmcnt(4)
    s_add_u32 s46, s22, 10240
    s_mov_b32 m0, s46
    s_add_u32 s45, s24, 425984
    buffer_load_dwordx4 v8, s[32:35], s45 offen lds
    s_add_u32 s45, s45, 15360
    buffer_load_dwordx4 v8, s[32:35], s45 offen offset:1024 lds
    s_waitcnt vmcnt(12)
    ds_read_b64_tr_b16 v[56:57], v9 offset:14336
    ds_read_b64_tr_b16 v[58:59], v9 offset:14848
    ds_read_b64_tr_b16 v[60:61], v10 offset:14336
    ds_read_b64_tr_b16 v[62:63], v10 offset:14848
    s_waitcnt lgkmcnt(4)
    s_add_u32 s46, s22, 12288
    s_mov_b32 m0, s46
    s_add_u32 s45, s24, 458752
    buffer_load_dwordx4 v8, s[32:35], s45 offen lds
    s_add_u32 s45, s45, 15360
    buffer_load_dwordx4 v8, s[32:35], s45 offen offset:1024 lds
    s_waitcnt vmcnt(12)
    ds_read_b64_tr_b16 v[64:65], v9 offset:0
    ds_read_b64_tr_b16 v[66:67], v9 offset:512
    ds_read_b64_tr_b16 v[68:69], v10 offset:0
    ds_read_b64_tr_b16 v[70:71], v10 offset:512
    s_waitcnt lgkmcnt(4)
    s_add_u32 s46, s22, 14336
    s_mov_b32 m0, s46
    s_add_u32 s45, s24, 491520
    buffer_load_dwordx4 v8, s[32:35], s45 offen lds
    s_add_u32 s45, s45, 15360
    buffer_load_dwordx4 v8, s[32:35], s45 offen offset:1024 lds
    s_waitcnt vmcnt(12)
    ds_read_b64_tr_b16 v[72:73], v9 offset:2048
    ds_read_b64_tr_b16 v[74:75], v9 offset:2560
    ds_read_b64_tr_b16 v[76:77], v10 offset:2048
    ds_read_b64_tr_b16 v[78:79], v10 offset:2560
    s_waitcnt lgkmcnt(4)
    s_add_u32 s46, s22, 0
    s_mov_b32 m0, s46
    s_add_u32 s45, s24, 524288
    buffer_load_dwordx4 v8, s[32:35], s45 offen lds
    s_add_u32 s45, s45, 15360
    buffer_load_dwordx4 v8, s[32:35], s45 offen offset:1024 lds
    s_waitcnt vmcnt(12)
    ds_read_b64_tr_b16 v[80:81], v9 offset:4096
    ds_read_b64_tr_b16 v[82:83], v9 offset:4608
    ds_read_b64_tr_b16 v[84:85], v10 offset:4096
    ds_read_b64_tr_b16 v[86:87], v10 offset:4608
    s_waitcnt lgkmcnt(4)
    s_add_u32 s46, s22, 2048
    s_mov_b32 m0, s46
    s_add_u32 s45, s24, 557056
    buffer_load_dwordx4 v8, s[32:35], s45 offen lds
    s_add_u32 s45, s45, 15360
    buffer_load_dwordx4 v8, s[32:35], s45 offen offset:1024 lds
    s_waitcnt vmcnt(12)
    ds_read_b64_tr_b16 v[88:89], v9 offset:6144
    ds_read_b64_tr_b16 v[90:91], v9 offset:6656
    ds_read_b64_tr_b16 v[92:93], v10 offset:6144
    ds_read_b64_tr_b16 v[94:95], v10 offset:6656
    s_waitcnt lgkmcnt(0)
    s_cmp_lg_u32 s40, 7
    s_cbranch_scc1 L1_nopoll
    v_mov_b32 v2, 0
    s_mov_b32 s54, 0x2000
L1_poll:
    global_load_dword v3, v2, s[50:51] sc1
    s_waitcnt vmcnt(0)
    v_readfirstlane_b32 s44, v3
    s_cmp_ge_u32 s44, 32
    s_cbranch_scc1 L1_polled
    s_sleep 1
    s_sub_u32 s54, s54, 1
    s_cmp_lg_u32 s54, 0
    s_cbranch_scc1 L1_poll
L1_polled:
L1_nopoll:
    s_barrier
    s_add_u32 s44, s23, 0
    buffer_load_dwordx4 a[64:67], v6, s[28:31], s44 offen offset:0 sc1
    buffer_load_dwordx4 a[68:71], v7, s[28:31], s44 offen offset:0 sc1
    buffer_load_dwordx4 a[72:75], v6, s[28:31], s44 offen offset:1024 sc1
    buffer_load_dwordx4 a[76:79], v7, s[28:31], s44 offen offset:1024 sc1
    buffer_load_dwordx4 a[80:83], v6, s[28:31], s44 offen offset:2048 sc1
    buffer_load_dwordx4 a[84:87], v7, s[28:31], s44 offen offset:2048 sc1
    buffer_load_dwordx4 a[88:91], v6, s[28:31], s44 offen offset:3072 sc1
    buffer_load_dwordx4 a[92:95], v7, s[28:31], s44 offen offset:3072 sc1
    s_waitcnt vmcnt(6)
    v_mfma_f32_32x32x16_bf16 a[0:15], a[128:131], a[64:67], 0
    s_add_u32 s44, s23, 4096
    buffer_load_dwordx4 a[96:99], v6, s[28:31], s44 offen offset:0 sc1
    v_mfma_f32_32x32x16_bf16 a[16:31], a[128:131], a[68:71], 0
    buffer_load_dwordx4 a[100:103], v7, s[28:31], s44 offen offset:0 sc1
    v_mfma_f32_32x32x16_bf16 a[32:47], a[132:135], a[64:67], 0
    s_add_u32 s46, s22, 4096
    s_mov_b32 m0, s46
    s_add_u32 s45, s24, 589824
    buffer_load_dwordx4 v8, s[32:35], s45 offen lds
    v_mfma_f32_32x32x16_bf16 a[48:63], a[132:135], a[68:71], 0
    s_add_u32 s45, s45, 15360
    buffer_load_dwordx4 v8, s[32:35], s45 offen offset:1024 lds
    s_waitcnt vmcnt(8)
    v_mfma_f32_32x32x16_bf16 a[0:15], a[136:139], a[72:75], a[0:15]
    buffer_load_dwordx4 a[104:107], v6, s[28:31], s44 offen offset:1024 sc1
    v_mfma_f32_32x32x16_bf16 a[16:31], a[136:139], a[76:79], a[16:31]
    buffer_load_dwordx4 a[108:111], v7, s[28:31], s44 offen offset:1024 sc1
    v_mfma_f32_32x32x16_bf16 a[32:47], a[140:143], a[72:75], a[32:47]
    s_add_u32 s46, s22, 6144
    s_mov_b32 m0, s46
    s_add_u32 s45, s24, 622592
    buffer_load_dwordx4 v8, s[32:35], s45 offen lds
    v_mfma_f32_32x32x16_bf16 a[48:63], a[140:143], a[76:79], a[48:63]
    s_add_u32 s45, s45, 15360
    buffer_load_dwordx4 v8, s[32:35], s45 offen offset:1024 lds
    s_waitcnt vmcnt(10)
    v_mfma_f32_32x32x16_bf16 a[0:15], a[144:147], a[80:83], a[0:15]
    buffer_load_dwordx4 a[64:67], v6, s[28:31], s44 offen offset:2048 sc1
    v_mfma_f32_32x32x16_bf16 a[16:31], a[144:147], a[84:87], a[16:31]
    v_mfma_f32_32x32x16_bf16 a[32:47], a[148:151], a[80:83], a[32:47]
    buffer_load_dwordx4 a[68:71], v7, s[28:31], s44 offen offset:2048 sc1
    v_mfma_f32_32x32x16_bf16 a[48:63], a[148:151], a[84:87], a[48:63]
    s_waitcnt vmcnt(10)
    v_mfma_f32_32x32x16_bf16 a[0:15], a[152:155], a[88:91], a[0:15]
    buffer_load_dwordx4 a[72:75], v6, s[28:31], s44 offen offset:3072 sc1
    v_mfma_f32_32x32x16_bf16 a[16:31], a[152:155], a[92:95], a[16:31]
    v_mfma_f32_32x32x16_bf16 a[32:47], a[156:159], a[88:91], a[32:47]
    buffer_load_dwordx4 a[76:79], v7, s[28:31], s44 offen offset:3072 sc1
    v_mfma_f32_32x32x16_bf16 a[48:63], a[156:159], a[92:95], a[48:63]
    s_waitcnt vmcnt(10)
    v_mfma_f32_32x32x16_bf16 a[0:15], v[32:35], a[96:99], a[0:15]
    s_add_u32 s44, s23, 8192
    buffer_load_dwordx4 a[80:83], v6, s[28:31], s44 offen offset:0 sc1
    v_mfma_f32_32x32x16_bf16 a[16:31], v[32:35], a[100:103], a[16:31]
    v_mfma_f32_32x32x16_bf16 a[32:47], v[36:39], a[96:99], a[32:47]
    buffer_load_dwordx4 a[84:87], v7, s[28:31], s44 offen offset:0 sc1
    v_mfma_f32_32x32x16_bf16 a[48:63], v[36:39], a[100:103], a[48:63]
    s_waitcnt vmcnt(8)
    v_mfma_f32_32x32x16_bf16 a[0:15], v[40:43], a[104:107], a[0:15]
    buffer_load_dwordx4 a[88:91], v6, s[28:31], s44 offen offset:1024 sc1
    v_mfma_f32_32x32x16_bf16 a[16:31], v[40:43], a[108:111], a[16:31]
    v_mfma_f32_32x32x16_bf16 a[32:47], v[44:47], a[104:107], a[32:47]
    buffer_load_dwordx4 a[92:95], v7, s[28:31], s44 offen offset:1024 sc1
    v_mfma_f32_32x32x16_bf16 a[48:63], v[44:47], a[108:111], a[48:63]
    s_waitcnt vmcnt(6)
    v_mfma_f32_32x32x16_bf16 a[0:15], v[48:51], a[64:67], a[0:15]
    buffer_load_dwordx4 a[96:99], v6, s[28:31], s44 offen offset:2048 sc1
    v_mfma_f32_32x32x16_bf16 a[16:31], v[48:51], a[68:71], a[16:31]
    v_mfma_f32_32x32x16_bf16 a[32:47], v[52:55], a[64:67], a[32:47]
    buffer_load_dwordx4 a[100:103], v7, s[28:31], s44 offen offset:2048 sc1
    v_mfma_f32_32x32x16_bf16 a[48:63], v[52:55], a[68:71], a[48:63]
    s_waitcnt vmcnt(6)
    v_mfma_f32_32x32x16_bf16 a[0:15], v[56:59], a[72:75], a[0:15]
    buffer_load_dwordx4 a[104:107], v6, s[28:31], s44 offen offset:3072 sc1
    v_mfma_f32_32x32x16_bf16 a[16:31], v[56:59], a[76:79], a[16:31]
    v_mfma_f32_32x32x16_bf16 a[32:47], v[60:63], a[72:75], a[32:47]
    buffer_load_dwordx4 a[108:111], v7, s[28:31], s44 offen offset:3072 sc1
    v_mfma_f32_32x32x16_bf16 a[48:63], v[60:63], a[76:79], a[48:63]
    s_waitcnt vmcnt(6)
    v_mfma_f32_32x32x16_bf16 a[0:15], v[64:67], a[80:83], a[0:15]
    s_add_u32 s44, s23, 12288
    buffer_load_dwordx4 a[64:67], v6, s[28:31], s44 offen offset:0 sc1
    v_mfma_f32_32x32x16_bf16 a[16:31], v[64:67], a[84:87], a[16:31]
    v_mfma_f32_32x32x16_bf16 a[32:47], v[68:71], a[80:83], a[32:47]
    buffer_load_dwordx4 a[68:71], v7, s[28:31], s44 offen offset:0 sc1
    v_mfma_f32_32x32x16_bf16 a[48:63], v[68:71], a[84:87], a[48:63]
    s_waitcnt vmcnt(6)
    v_mfma_f32_32x32x16_bf16 a[0:15], v[72:75], a[88:91], a[0:15]
    buffer_load_dwordx4 a[72:75], v6, s[28:31], s44 offen offset:1024 sc1
    v_mfma_f32_32x32x16_bf16 a[16:31], v[72:75], a[92:95], a[16:31]
    v_mfma_f32_32x32x16_bf16 a[32:47], v[76:79], a[88:91], a[32:47]
    buffer_load_dwordx4 a[76:79], v7, s[28:31], s44 offen offset:1024 sc1
    v_mfma_f32_32x32x16_bf16 a[48:63], v[76:79], a[92:95], a[48:63]
    s_waitcnt vmcnt(6)
    v_mfma_f32_32x32x16_bf16 a[0:15], v[80:83], a[96:99], a[0:15]
    buffer_load_dwordx4 a[80:83], v6, s[28:31], s44 offen offset:2048 sc1
    v_mfma_f32_32x32x16_bf16 a[16:31], v[80:83], a[100:103], a[16:31]
    v_mfma_f32_32x32x16_bf16 a[32:47], v[84:87], a[96:99], a[32:47]
    buffer_load_dwordx4 a[84:87], v7, s[28:31], s44 offen offset:2048 sc1
    v_mfma_f32_32x32x16_bf16 a[48:63], v[84:87], a[100:103], a[48:63]
    s_waitcnt vmcnt(6)
    v_mfma_f32_32x32x16_bf16 a[0:15], v[88:91], a[104:107], a[0:15]
    buffer_load_dwordx4 a[88:91], v6, s[28:31], s44 offen offset:3072 sc1
    v_mfma_f32_32x32x16_bf16 a[16:31], v[88:91], a[108:111], a[16:31]
    buffer_load_dwordx4 a[92:95], v7, s[28:31], s44 offen offset:3072 sc1
    v_mfma_f32_32x32x16_bf16 a[32:47], v[92:95], a[104:107], a[32:47]
    ds_read_b64_tr_b16 a[112:113], v9 offset:8192
    ds_read_b64_tr_b16 a[114:115], v9 offset:8704
    v_mfma_f32_32x32x16_bf16 a[48:63], v[92:95], a[108:111], a[48:63]
    ds_read_b64_tr_b16 a[116:117], v10 offset:8192
    ds_read_b64_tr_b16 a[118:119], v10 offset:8704
    s_waitcnt vmcnt(6)
    s_waitcnt lgkmcnt(0)
    v_mfma_f32_32x32x16_bf16 a[0:15], a[112:115], a[64:67], a[0:15]
    s_add_u32 s44, s23, 16384
    buffer_load_dwordx4 a[96:99], v6, s[28:31], s44 offen offset:0 sc1
    v_mfma_f32_32x32x16_bf16 a[16:31], a[112:115], a[68:71], a[16:31]
    buffer_load_dwordx4 a[100:103], v7, s[28:31], s44 offen offset:0 sc1
    v_mfma_f32_32x32x16_bf16 a[32:47], a[116:119], a[64:67], a[32:47]
    ds_read_b64_tr_b16 a[120:121], v9 offset:10240
    ds_read_b64_tr_b16 a[122:123], v9 offset:10752
    v_mfma_f32_32x32x16_bf16 a[48:63], a[116:119], a[68:71], a[48:63]
    ds_read_b64_tr_b16 a[124:125], v10 offset:10240
    ds_read_b64_tr_b16 a[126:127], v10 offset:10752
    s_waitcnt vmcnt(6)
    s_waitcnt lgkmcnt(0)
    v_mfma_f32_32x32x16_bf16 a[0:15], a[120:123], a[72:75], a[0:15]
    buffer_load_dwordx4 a[104:107], v6, s[28:31], s44 offen offset:1024 sc1
    buffer_load_dwordx4 a[108:111], v7, s[28:31], s44 offen offset:1024 sc1
    v_mfma_f32_32x32x16_bf16 a[16:31], a[120:123], a[76:79], a[16:31]
    s_add_u32 s46, s22, 8192
    s_mov_b32 m0, s46
    s_add_u32 s45, s24, 655360
    buffer_load_dwordx4 v8, s[32:35], s45 offen lds
    v_mfma_f32_32x32x16_bf16 a[32:47], a[124:127], a[72:75], a[32:47]
    s_add_u32 s45, s45, 15360
    buffer_load_dwordx4 v8, s[32:35], s45 offen offset:1024 lds
    ds_read_b64_tr_b16 a[112:113], v9 offset:12288
    v_mfma_f32_32x32x16_bf16 a[48:63], a[124:127], a[76:79], a[48:63]
    ds_read_b64_tr_b16 a[114:115], v9 offset:12800
    ds_read_b64_tr_b16 a[116:117], v10 offset:12288
    ds_read_b64_tr_b16 a[118:119], v10 offset:12800
    s_waitcnt vmcnt(8)
    s_waitcnt lgkmcnt(0)
    v_mfma_f32_32x32x16_bf16 a[0:15], a[112:115], a[80:83], a[0:15]
    buffer_load_dwordx4 a[64:67], v6, s[28:31], s44 offen offset:2048 sc1
    buffer_load_dwordx4 a[68:71], v7, s[28:31], s44 offen offset:2048 sc1
    v_mfma_f32_32x32x16_bf16 a[16:31], a[112:115], a[84:87], a[16:31]
    s_add_u32 s46, s22, 10240
    s_mov_b32 m0, s46
    s_add_u32 s45, s24, 688128
    buffer_load_dwordx4 v8, s[32:35], s45 offen lds
    v_mfma_f32_32x32x16_bf16 a[32:47], a[116:119], a[80:83], a[32:47]
    s_add_u32 s45, s45, 15360
    buffer_load_dwordx4 v8, s[32:35], s45 offen offset:1024 lds
    ds_read_b64_tr_b16 a[120:121], v9 offset:14336
    v_mfma_f32_32x32x16_bf16 a[48:63], a[116:119], a[84:87], a[48:63]
    ds_read_b64_tr_b16 a[122:123], v9 offset:14848
    ds_read_b64_tr_b16 a[124:125], v10 offset:14336
    ds_read_b64_tr_b16 a[126:127], v10 offset:14848
    s_waitcnt vmcnt(10)
    s_waitcnt lgkmcnt(0)
    v_mfma_f32_32x32x16_bf16 a[0:15], a[120:123], a[88:91], a[0:15]
    buffer_load_dwordx4 a[72:75], v6, s[28:31], s44 offen offset:3072 sc1
    buffer_load_dwordx4 a[76:79], v7, s[28:31], s44 offen offset:3072 sc1
    v_mfma_f32_32x32x16_bf16 a[16:31], a[120:123], a[92:95], a[16:31]
    s_add_u32 s46, s22, 12288
    s_mov_b32 m0, s46
    s_add_u32 s45, s24, 720896
    buffer_load_dwordx4 v8, s[32:35], s45 offen lds
    v_mfma_f32_32x32x16_bf16 a[32:47], a[124:127], a[88:91], a[32:47]
    s_add_u32 s45, s45, 15360
    buffer_load_dwordx4 v8, s[32:35], s45 offen offset:1024 lds
    ds_read_b64_tr_b16 a[112:113], v9 offset:0
    v_mfma_f32_32x32x16_bf16 a[48:63], a[124:127], a[92:95], a[48:63]
    ds_read_b64_tr_b16 a[114:115], v9 offset:512
    ds_read_b64_tr_b16 a[116:117], v10 offset:0
    ds_read_b64_tr_b16 a[118:119], v10 offset:512
    s_waitcnt vmcnt(12)
    s_waitcnt lgkmcnt(0)
    v_mfma_f32_32x32x16_bf16 a[0:15], a[112:115], a[96:99], a[0:15]
    s_add_u32 s44, s23, 20480
    buffer_load_dwordx4 a[80:83], v6, s[28:31], s44 offen offset:0 sc1
    buffer_load_dwordx4 a[84:87], v7, s[28:31], s44 offen offset:0 sc1
    v_mfma_f32_32x32x16_bf16 a[16:31], a[112:115], a[100:103], a[16:31]
    s_add_u32 s46, s22, 14336
    s_mov_b32 m0, s46
    s_add_u32 s45, s24, 753664
    buffer_load_dwordx4 v8, s[32:35], s45 offen lds
    v_mfma_f32_32x32x16_bf16 a[32:47], a[116:119], a[96:99], a[32:47]
    s_add_u32 s45, s45, 15360
    buffer_load_dwordx4 v8, s[32:35], s45 offen offset:1024 lds
    ds_read_b64_tr_b16 a[120:121], v9 offset:2048
    v_mfma_f32_32x32x16_bf16 a[48:63], a[116:119], a[100:103], a[48:63]
    ds_read_b64_tr_b16 a[122:123], v9 offset:2560
    ds_read_b64_tr_b16 a[124:125], v10 offset:2048
    ds_read_b64_tr_b16 a[126:127], v10 offset:2560
    s_waitcnt vmcnt(14)
    s_waitcnt lgkmcnt(0)
    v_mfma_f32_32x32x16_bf16 a[0:15], a[120:123], a[104:107], a[0:15]
    buffer_load_dwordx4 a[88:91], v6, s[28:31], s44 offen offset:1024 sc1
    buffer_load_dwordx4 a[92:95], v7, s[28:31], s44 offen offset:1024 sc1
    v_mfma_f32_32x32x16_bf16 a[16:31], a[120:123], a[108:111], a[16:31]
    s_add_u32 s46, s22, 0
    s_mov_b32 m0, s46
    s_add_u32 s45, s24, 786432
    buffer_load_dwordx4 v8, s[32:35], s45 offen lds
    v_mfma_f32_32x32x16_bf16 a[32:47], a[124:127], a[104:107], a[32:47]
    s_add_u32 s45, s45, 15360
    buffer_load_dwordx4 v8, s[32:35], s45 offen offset:1024 lds
    ds_read_b64_tr_b16 a[112:113], v9 offset:4096
    v_mfma_f32_32x32x16_bf16 a[48:63], a[124:127], a[108:111], a[48:63]
    ds_read_b64_tr_b16 a[114:115], v9 offset:4608
    ds_read_b64_tr_b16 a[116:117], v10 offset:4096
    ds_read_b64_tr_b16 a[118:119], v10 offset:4608
    s_waitcnt vmcnt(14)
    s_waitcnt lgkmcnt(0)
    v_mfma_f32_32x32x16_bf16 a[0:15], a[112:115], a[64:67], a[0:15]
    buffer_load_dwordx4 a[96:99], v6, s[28:31], s44 offen offset:2048 sc1
    buffer_load_dwordx4 a[100:103], v7, s[28:31], s44 offen offset:2048 sc1
    v_mfma_f32_32x32x16_bf16 a[16:31], a[112:115], a[68:71], a[16:31]
    s_add_u32 s46, s22, 2048
    s_mov_b32 m0, s46
    s_add_u32 s45, s24, 819200
    buffer_load_dwordx4 v8, s[32:35], s45 offen lds
    v_mfma_f32_32x32x16_bf16 a[32:47], a[116:119], a[64:67], a[32:47]
    s_add_u32 s45, s45, 15360
    buffer_load_dwordx4 v8, s[32:35], s45 offen offset:1024 lds
    ds_read_b64_tr_b16 a[120:121], v9 offset:6144
    v_mfma_f32_32x32x16_bf16 a[48:63], a[116:119], a[68:71], a[48:63]
    ds_read_b64_tr_b16 a[122:123], v9 offset:6656
    ds_read_b64_tr_b16 a[124:125], v10 offset:6144
    ds_read_b64_tr_b16 a[126:127], v10 offset:6656
    s_waitcnt vmcnt(14)
    s_waitcnt lgkmcnt(0)
    v_mfma_f32_32x32x16_bf16 a[0:15], a[120:123], a[72:75], a[0:15]
    buffer_load_dwordx4 a[104:107], v6, s[28:31], s44 offen offset:3072 sc1
    buffer_load_dwordx4 a[108:111], v7, s[28:31], s44 offen offset:3072 sc1
    v_mfma_f32_32x32x16_bf16 a[16:31], a[120:123], a[76:79], a[16:31]
    s_add_u32 s46, s22, 4096
    s_mov_b32 m0, s46
    s_add_u32 s45, s24, 851968
    buffer_load_dwordx4 v8, s[32:35], s45 offen lds
    v_mfma_f32_32x32x16_bf16 a[32:47], a[124:127], a[72:75], a[32:47]
    s_add_u32 s45, s45, 15360
    buffer_load_dwordx4 v8, s[32:35], s45 offen offset:1024 lds
    ds_read_b64_tr_b16 a[112:113], v9 offset:8192
    v_mfma_f32_32x32x16_bf16 a[48:63], a[124:127], a[76:79], a[48:63]
    ds_read_b64_tr_b16 a[114:115], v9 offset:8704
    ds_read_b64_tr_b16 a[116:117], v10 offset:8192
    ds_read_b64_tr_b16 a[118:119], v10 offset:8704
    s_waitcnt vmcnt(14)
    s_waitcnt lgkmcnt(0)
    v_mfma_f32_32x32x16_bf16 a[0:15], a[112:115], a[80:83], a[0:15]
    s_add_u32 s44, s23, 24576
    buffer_load_dwordx4 a[64:67], v6, s[28:31], s44 offen offset:0 sc1
    buffer_load_dwordx4 a[68:71], v7, s[28:31], s44 offen offset:0 sc1
    v_mfma_f32_32x32x16_bf16 a[16:31], a[112:115], a[84:87], a[16:31]
    s_add_u32 s46, s22, 6144
    s_mov_b32 m0, s46
    s_add_u32 s45, s24, 884736
    buffer_load_dwordx4 v8, s[32:35], s45 offen lds
    v_mfma_f32_32x32x16_bf16 a[32:47], a[116:119], a[80:83], a[32:47]
    s_add_u32 s45, s45, 15360
    buffer_load_dwordx4 v8, s[32:35], s45 offen offset:1024 lds
    ds_read_b64_tr_b16 a[120:121], v9 offset:10240
    v_mfma_f32_32x32x16_bf16 a[48:63], a[116:119], a[84:87], a[48:63]
    ds_read_b64_tr_b16 a[122:123], v9 offset:10752
    ds_read_b64_tr_b16 a[124:125], v10 offset:10240
    ds_read_b64_tr_b16 a[126:127], v10 offset:10752
    s_waitcnt vmcnt(14)
    s_waitcnt lgkmcnt(0)
    v_mfma_f32_32x32x16_bf16 a[0:15], a[120:123], a[88:91], a[0:15]
    buffer_load_dwordx4 a[72:75], v6, s[28:31], s44 offen offset:1024 sc1
    buffer_load_dwordx4 a[76:79], v7, s[28:31], s44 offen offset:1024 sc1
    v_mfma_f32_32x32x16_bf16 a[16:31], a[120:123], a[92:95], a[16:31]
    s_add_u32 s46, s22, 8192
    s_mov_b32 m0, s46
    s_add_u32 s45, s24, 917504
    buffer_load_dwordx4 v8, s[32:35], s45 offen lds
    v_mfma_f32_32x32x16_bf16 a[32:47], a[124:127], a[88:91], a[32:47]
    s_add_u32 s45, s45, 15360
    buffer_load_dwordx4 v8, s[32:35], s45 offen offset:1024 lds
    ds_read_b64_tr_b16 a[112:113], v9 offset:12288
    v_mfma_f32_32x32x16_bf16 a[48:63], a[124:127], a[92:95], a[48:63]
    ds_read_b64_tr_b16 a[114:115], v9 offset:12800
    ds_read_b64_tr_b16 a[116:117], v10 offset:12288
    ds_read_b64_tr_b16 a[118:119], v10 offset:12800
    s_waitcnt vmcnt(14)
    s_waitcnt lgkmcnt(0)
    v_mfma_f32_32x32x16_bf16 a[0:15], a[112:115], a[96:99], a[0:15]
    buffer_load_dwordx4 a[80:83], v6, s[28:31], s44 offen offset:2048 sc1
    buffer_load_dwordx4 a[84:87], v7, s[28:31], s44 offen offset:2048 sc1
    v_mfma_f32_32x32x16_bf16 a[16:31], a[112:115], a[100:103], a[16:31]
    s_add_u32 s46, s22, 10240
    s_mov_b32 m0, s46
    s_add_u32 s45, s24, 950272
    buffer_load_dwordx4 v8, s[32:35], s45 offen lds
    v_mfma_f32_32x32x16_bf16 a[32:47], a[116:119], a[96:99], a[32:47]
    s_add_u32 s45, s45, 15360
    buffer_load_dwordx4 v8, s[32:35], s45 offen offset:1024 lds
    ds_read_b64_tr_b16 a[120:121], v9 offset:14336
    v_mfma_f32_32x32x16_bf16 a[48:63], a[116:119], a[100:103], a[48:63]
    ds_read_b64_tr_b16 a[122:123], v9 offset:14848
    ds_read_b64_tr_b16 a[124:125], v10 offset:14336
    ds_read_b64_tr_b16 a[126:127], v10 offset:14848
    s_waitcnt vmcnt(14)
    s_waitcnt lgkmcnt(0)
    v_mfma_f32_32x32x16_bf16 a[0:15], a[120:123], a[104:107], a[0:15]
    buffer_load_dwordx4 a[88:91], v6, s[28:31], s44 offen offset:3072 sc1
    buffer_load_dwordx4 a[92:95], v7, s[28:31], s44 offen offset:3072 sc1
    v_mfma_f32_32x32x16_bf16 a[16:31], a[120:123], a[108:111], a[16:31]
    s_add_u32 s46, s22, 12288
    s_mov_b32 m0, s46
    s_add_u32 s45, s24, 983040
    buffer_load_dwordx4 v8, s[32:35], s45 offen lds
    v_mfma_f32_32x32x16_bf16 a[32:47], a[124:127], a[104:107], a[32:47]
    s_add_u32 s45, s45, 15360
    buffer_load_dwordx4 v8, s[32:35], s45 offen offset:1024 lds
    ds_read_b64_tr_b16 a[112:113], v9 offset:0
    v_mfma_f32_32x32x16_bf16 a[48:63], a[124:127], a[108:111], a[48:63]
    ds_read_b64_tr_b16 a[114:115], v9 offset:512
    ds_read_b64_tr_b16 a[116:117], v10 offset:0
    ds_read_b64_tr_b16 a[118:119], v10 offset:512
    s_waitcnt vmcnt(14)
    s_waitcnt lgkmcnt(0)
    v_mfma_f32_32x32x16_bf16 a[0:15], a[112:115], a[64:67], a[0:15]
    s_add_u32 s44, s23, 28672
    buffer_load_dwordx4 a[96:99], v6, s[28:31], s44 offen offset:0 sc1
    buffer_load_dwordx4 a[100:103], v7, s[28:31], s44 offen offset:0 sc1
    v_mfma_f32_32x32x16_bf16 a[16:31], a[112:115], a[68:71], a[16:31]
    s_add_u32 s46, s22, 14336
    s_mov_b32 m0, s46
    s_add_u32 s45, s24, 1015808
    buffer_load_dwordx4 v8, s[32:35], s45 offen lds
    v_mfma_f32_32x32x16_bf16 a[32:47], a[116:119], a[64:67], a[32:47]
    s_add_u32 s45, s45, 15360
    buffer_load_dwordx4 v8, s[32:35], s45 offen offset:1024 lds
    ds_read_b64_tr_b16 a[120:121], v9 offset:2048
    v_mfma_f32_32x32x16_bf16 a[48:63], a[116:119], a[68:71], a[48:63]
    ds_read_b64_tr_b16 a[122:123], v9 offset:2560
    ds_read_b64_tr_b16 a[124:125], v10 offset:2048
    ds_read_b64_tr_b16 a[126:127], v10 offset:2560
    s_waitcnt vmcnt(14)
    s_waitcnt lgkmcnt(0)
    v_mfma_f32_32x32x16_bf16 a[0:15], a[120:123], a[72:75], a[0:15]
    buffer_load_dwordx4 a[104:107], v6, s[28:31], s44 offen offset:1024 sc1
    v_mfma_f32_32x32x16_bf16 a[16:31], a[120:123], a[76:79], a[16:31]
    buffer_load_dwordx4 a[108:111], v7, s[28:31], s44 offen offset:1024 sc1
    v_mfma_f32_32x32x16_bf16 a[32:47], a[124:127], a[72:75], a[32:47]
    ds_read_b64_tr_b16 a[112:113], v9 offset:4096
    ds_read_b64_tr_b16 a[114:115], v9 offset:4608
    v_mfma_f32_32x32x16_bf16 a[48:63], a[124:127], a[76:79], a[48:63]
    ds_read_b64_tr_b16 a[116:117], v10 offset:4096
    ds_read_b64_tr_b16 a[118:119], v10 offset:4608
    s_waitcnt vmcnt(12)
    s_waitcnt lgkmcnt(0)
    v_mfma_f32_32x32x16_bf16 a[0:15], a[112:115], a[80:83], a[0:15]
    buffer_load_dwordx4 a[64:67], v6, s[28:31], s44 offen offset:2048 sc1
    v_mfma_f32_32x32x16_bf16 a[16:31], a[112:115], a[84:87], a[16:31]
    buffer_load_dwordx4 a[68:71], v7, s[28:31], s44 offen offset:2048 sc1
    v_mfma_f32_32x32x16_bf16 a[32:47], a[116:119], a[80:83], a[32:47]
    ds_read_b64_tr_b16 a[120:121], v9 offset:6144
    ds_read_b64_tr_b16 a[122:123], v9 offset:6656
    v_mfma_f32_32x32x16_bf16 a[48:63], a[116:119], a[84:87], a[48:63]
    ds_read_b64_tr_b16 a[124:125], v10 offset:6144
    ds_read_b64_tr_b16 a[126:127], v10 offset:6656
    s_waitcnt vmcnt(10)
    s_waitcnt lgkmcnt(0)
    v_mfma_f32_32x32x16_bf16 a[0:15], a[120:123], a[88:91], a[0:15]
    buffer_load_dwordx4 a[72:75], v6, s[28:31], s44 offen offset:3072 sc1
    v_mfma_f32_32x32x16_bf16 a[16:31], a[120:123], a[92:95], a[16:31]
    buffer_load_dwordx4 a[76:79], v7, s[28:31], s44 offen offset:3072 sc1
    v_mfma_f32_32x32x16_bf16 a[32:47], a[124:127], a[88:91], a[32:47]
    ds_read_b64_tr_b16 a[112:113], v9 offset:8192
    ds_read_b64_tr_b16 a[114:115], v9 offset:8704
    v_mfma_f32_32x32x16_bf16 a[48:63], a[124:127], a[92:95], a[48:63]
    ds_read_b64_tr_b16 a[116:117], v10 offset:8192
    ds_read_b64_tr_b16 a[118:119], v10 offset:8704
    s_waitcnt vmcnt(8)
    s_waitcnt lgkmcnt(0)
    v_mfma_f32_32x32x16_bf16 a[0:15], a[112:115], a[96:99], a[0:15]
    ds_read_b64_tr_b16 a[120:121], v9 offset:10240
    v_mfma_f32_32x32x16_bf16 a[16:31], a[112:115], a[100:103], a[16:31]
    ds_read_b64_tr_b16 a[122:123], v9 offset:10752
    v_mfma_f32_32x32x16_bf16 a[32:47], a[116:119], a[96:99], a[32:47]
    ds_read_b64_tr_b16 a[124:125], v10 offset:10240
    v_mfma_f32_32x32x16_bf16 a[48:63], a[116:119], a[100:103], a[48:63]
    ds_read_b64_tr_b16 a[126:127], v10 offset:10752
    s_waitcnt vmcnt(4)
    s_waitcnt lgkmcnt(0)
    v_mfma_f32_32x32x16_bf16 a[0:15], a[120:123], a[104:107], a[0:15]
    ds_read_b64_tr_b16 a[112:113], v9 offset:12288
    v_mfma_f32_32x32x16_bf16 a[16:31], a[120:123], a[108:111], a[16:31]
    ds_read_b64_tr_b16 a[114:115], v9 offset:12800
    v_mfma_f32_32x32x16_bf16 a[32:47], a[124:127], a[104:107], a[32:47]
    ds_read_b64_tr_b16 a[116:117], v10 offset:12288
    v_mfma_f32_32x32x16_bf16 a[48:63], a[124:127], a[108:111], a[48:63]
    ds_read_b64_tr_b16 a[118:119], v10 offset:12800
    s_waitcnt vmcnt(2)
    s_waitcnt lgkmcnt(0)
    v_mfma_f32_32x32x16_bf16 a[0:15], a[112:115], a[64:67], a[0:15]
    ds_read_b64_tr_b16 a[120:121], v9 offset:14336
    v_mfma_f32_32x32x16_bf16 a[16:31], a[112:115], a[68:71], a[16:31]
    ds_read_b64_tr_b16 a[122:123], v9 offset:14848
    v_mfma_f32_32x32x16_bf16 a[32:47], a[116:119], a[64:67], a[32:47]
    ds_read_b64_tr_b16 a[124:125], v10 offset:14336
    v_mfma_f32_32x32x16_bf16 a[48:63], a[116:119], a[68:71], a[48:63]
    ds_read_b64_tr_b16 a[126:127], v10 offset:14848
    s_waitcnt vmcnt(0)
    s_waitcnt lgkmcnt(0)
    v_mfma_f32_32x32x16_bf16 a[0:15], a[120:123], a[72:75], a[0:15]
    v_mfma_f32_32x32x16_bf16 a[16:31], a[120:123], a[76:79], a[16:31]
    v_mfma_f32_32x32x16_bf16 a[32:47], a[124:127], a[72:75], a[32:47]
    v_mfma_f32_32x32x16_bf16 a[48:63], a[124:127], a[76:79], a[48:63]
    s_barrier
    s_nop 7
    s_nop 3
    s_lshl_b32 s44, s40, 11
    v_add_u32 v2, s44, v11
    v_add_u32 v3, 65536, v2
    ds_write_b128 v2, a[0:3] offset:0
    ds_write_b128 v2, a[4:7] offset:1024
    ds_write_b128 v2, a[8:11] offset:16384
    ds_write_b128 v2, a[12:15] offset:17408
    ds_write_b128 v2, a[16:19] offset:32768
    ds_write_b128 v2, a[20:23] offset:33792
    ds_write_b128 v2, a[24:27] offset:49152
    ds_write_b128 v2, a[28:31] offset:50176
    ds_write_b128 v3, a[32:35] offset:0
    ds_write_b128 v3, a[36:39] offset:1024
    ds_write_b128 v3, a[40:43] offset:16384
    ds_write_b128 v3, a[44:47] offset:17408
    ds_write_b128 v3, a[48:51] offset:32768
    ds_write_b128 v3, a[52:55] offset:33792
    ds_write_b128 v3, a[56:59] offset:49152
    ds_write_b128 v3, a[60:63] offset:50176
    s_waitcnt lgkmcnt(0)
    s_barrier
    v_add_u32 v2, s22, v11
    ds_read_b128 v[32:35], v2 offset:0
    ds_read_b128 v[36:39], v2 offset:1024
    ds_read_b128 v[40:43], v2 offset:2048
    ds_read_b128 v[44:47], v2 offset:3072
    ds_read_b128 v[48:51], v2 offset:4096
    ds_read_b128 v[52:55], v2 offset:5120
    ds_read_b128 v[56:59], v2 offset:6144
    ds_read_b128 v[60:63], v2 offset:7168
    ds_read_b128 v[64:67], v2 offset:8192
    ds_read_b128 v[68:71], v2 offset:9216
    ds_read_b128 v[72:75], v2 offset:10240
    ds_read_b128 v[76:79], v2 offset:11264
    ds_read_b128 v[80:83], v2 offset:12288
    ds_read_b128 v[84:87], v2 offset:13312
    ds_read_b128 v[88:91], v2 offset:14336
    ds_read_b128 v[92:95], v2 offset:15360
    s_waitcnt lgkmcnt(12)
    v_add_f32 v32, v32, v40
    v_add_f32 v33, v33, v41
    v_add_f32 v34, v34, v42
    v_add_f32 v35, v35, v43
    v_add_f32 v36, v36, v44
    v_add_f32 v37, v37, v45
    v_add_f32 v38, v38, v46
    v_add_f32 v39, v39, v47
    s_waitcnt lgkmcnt(8)
    v_add_f32 v48, v48, v56
    v_add_f32 v49, v49, v57
    v_add_f32 v50, v50, v58
    v_add_f32 v51, v51, v59
    v_add_f32 v52, v52, v60
    v_add_f32 v53, v53, v61
    v_add_f32 v54, v54, v62
    v_add_f32 v55, v55, v63
    s_waitcnt lgkmcnt(4)
    v_add_f32 v64, v64, v72
    v_add_f32 v65, v65, v73
    v_add_f32 v66, v66, v74
    v_add_f32 v67, v67, v75
    v_add_f32 v68, v68, v76
    v_add_f32 v69, v69, v77
    v_add_f32 v70, v70, v78
    v_add_f32 v71, v71, v79
    s_waitcnt lgkmcnt(0)
    v_add_f32 v80, v80, v88
    v_add_f32 v81, v81, v89
    v_add_f32 v82, v82, v90
    v_add_f32 v83, v83, v91
    v_add_f32 v84, v84, v92
    v_add_f32 v85, v85, v93
    v_add_f32 v86, v86, v94
    v_add_f32 v87, v87, v95
    v_add_f32 v32, v32, v48
    v_add_f32 v64, v64, v80
    v_add_f32 v33, v33, v49
    v_add_f32 v65, v65, v81
    v_add_f32 v34, v34, v50
    v_add_f32 v66, v66, v82
    v_add_f32 v35, v35, v51
    v_add_f32 v67, v67, v83
    v_add_f32 v36, v36, v52
    v_add_f32 v68, v68, v84
    v_add_f32 v37, v37, v53
    v_add_f32 v69, v69, v85
    v_add_f32 v38, v38, v54
    v_add_f32 v70, v70, v86
    v_add_f32 v39, v39, v55
    v_add_f32 v71, v71, v87
    v_add_f32 v32, v32, v64
    v_add_f32 v33, v33, v65
    v_add_f32 v34, v34, v66
    v_add_f32 v35, v35, v67
    v_add_f32 v36, v36, v68
    v_add_f32 v37, v37, v69
    v_add_f32 v38, v38, v70
    v_add_f32 v39, v39, v71
    v_cvt_pk_bf16_f32 v48, v32, v33
    v_cvt_pk_bf16_f32 v49, v34, v35
    v_cvt_pk_bf16_f32 v50, v36, v37
    v_cvt_pk_bf16_f32 v51, v38, v39
    buffer_store_dwordx4 v[48:51], v12, s[36:39], 0 offen
L1_end:
    s_endpgm
L1_rare0:
    s_nop 15
    s_nop 15
    v_mov_b32 v3, v8
    s_nop 1
    v_permlane32_swap_b32 v8, v3
    s_nop 1
    v_max_f32 v8, v8, v3
    v_max_f32 v8, 0, v8
    v_sub_f32 v3, 0, v8
    v_exp_f32 v3, v3
    v_sub_f32 v32, v32, v8
    v_sub_f32 v80, v80, v8
    v_sub_f32 v33, v33, v8
    v_sub_f32 v81, v81, v8
    v_sub_f32 v34, v34, v8
    v_sub_f32 v82, v82, v8
    v_sub_f32 v35, v35, v8
    v_sub_f32 v83, v83, v8
    v_sub_f32 v36, v36, v8
    v_sub_f32 v84, v84, v8
    v_sub_f32 v37, v37, v8
    v_sub_f32 v85, v85, v8
    v_sub_f32 v38, v38, v8
    v_sub_f32 v86, v86, v8
    v_sub_f32 v39, v39, v8
    v_sub_f32 v87, v87, v8
    v_sub_f32 v40, v40, v8
    v_sub_f32 v88, v88, v8
    v_sub_f32 v41, v41, v8
    v_sub_f32 v89, v89, v8
    v_sub_f32 v42, v42, v8
    v_sub_f32 v90, v90, v8
    v_sub_f32 v43, v43, v8
    v_sub_f32 v91, v91, v8
    v_sub_f32 v44, v44, v8
    v_sub_f32 v92, v92, v8
    v_sub_f32 v45, v45, v8
    v_sub_f32 v93, v93, v8
    v_sub_f32 v46, v46, v8
    v_sub_f32 v94, v94, v8
    v_sub_f32 v47, v47, v8
    v_sub_f32 v95, v95, v8
    v_accvgpr_read_b32 v4, a0
    v_mul_f32 v4, v3, v4
    v_accvgpr_write_b32 a0, v4
    v_accvgpr_read_b32 v4, a1
    v_mul_f32 v4, v3, v4
    v_accvgpr_write_b32 a1, v4
    v_accvgpr_read_b32 v4, a2
    v_mul_f32 v4, v3, v4
    v_accvgpr_write_b32 a2, v4
    v_accvgpr_read_b32 v4, a3
    v_mul_f32 v4, v3, v4
    v_accvgpr_write_b32 a3, v4
    v_accvgpr_read_b32 v4, a4
    v_mul_f32 v4, v3, v4
    v_accvgpr_write_b32 a4, v4
    v_accvgpr_read_b32 v4, a5
    v_mul_f32 v4, v3, v4
    v_accvgpr_write_b32 a5, v4
    v_accvgpr_read_b32 v4, a6
    v_mul_f32 v4, v3, v4
    v_accvgpr_write_b32 a6, v4
    v_accvgpr_read_b32 v4, a7
    v_mul_f32 v4, v3, v4
    v_accvgpr_write_b32 a7, v4
    v_accvgpr_read_b32 v4, a8
    v_mul_f32 v4, v3, v4
    v_accvgpr_write_b32 a8, v4
    v_accvgpr_read_b32 v4, a9
    v_mul_f32 v4, v3, v4
    v_accvgpr_write_b32 a9, v4
    v_accvgpr_read_b32 v4, a10
    v_mul_f32 v4, v3, v4
    v_accvgpr_write_b32 a10, v4
    v_accvgpr_read_b32 v4, a11
    v_mul_f32 v4, v3, v4
    v_accvgpr_write_b32 a11, v4
    v_accvgpr_read_b32 v4, a12
    v_mul_f32 v4, v3, v4
    v_accvgpr_write_b32 a12, v4
    v_accvgpr_read_b32 v4, a13
    v_mul_f32 v4, v3, v4
    v_accvgpr_write_b32 a13, v4
    v_accvgpr_read_b32 v4, a14
    v_mul_f32 v4, v3, v4
    v_accvgpr_write_b32 a14, v4
    v_accvgpr_read_b32 v4, a15
    v_mul_f32 v4, v3, v4
    v_accvgpr_write_b32 a15, v4
    v_accvgpr_read_b32 v4, a16
    v_mul_f32 v4, v3, v4
    v_accvgpr_write_b32 a16, v4
    v_accvgpr_read_b32 v4, a17
    v_mul_f32 v4, v3, v4
    v_accvgpr_write_b32 a17, v4
    v_accvgpr_read_b32 v4, a18
    v_mul_f32 v4, v3, v4
    v_accvgpr_write_b32 a18, v4
    v_accvgpr_read_b32 v4, a19
    v_mul_f32 v4, v3, v4
    v_accvgpr_write_b32 a19, v4
    v_accvgpr_read_b32 v4, a20
    v_mul_f32 v4, v3, v4
    v_accvgpr_write_b32 a20, v4
    v_accvgpr_read_b32 v4, a21
    v_mul_f32 v4, v3, v4
    v_accvgpr_write_b32 a21, v4
    v_accvgpr_read_b32 v4, a22
    v_mul_f32 v4, v3, v4
    v_accvgpr_write_b32 a22, v4
    v_accvgpr_read_b32 v4, a23
    v_mul_f32 v4, v3, v4
    v_accvgpr_write_b32 a23, v4
    v_accvgpr_read_b32 v4, a24
    v_mul_f32 v4, v3, v4
    v_accvgpr_write_b32 a24, v4
    v_accvgpr_read_b32 v4, a25
    v_mul_f32 v4, v3, v4
    v_accvgpr_write_b32 a25, v4
    v_accvgpr_read_b32 v4, a26
    v_mul_f32 v4, v3, v4
    v_accvgpr_write_b32 a26, v4
    v_accvgpr_read_b32 v4, a27
    v_mul_f32 v4, v3, v4
    v_accvgpr_write_b32 a27, v4
    v_accvgpr_read_b32 v4, a28
    v_mul_f32 v4, v3, v4
    v_accvgpr_write_b32 a28, v4
    v_accvgpr_read_b32 v4, a29
    v_mul_f32 v4, v3, v4
    v_accvgpr_write_b32 a29, v4
    v_accvgpr_read_b32 v4, a30
    v_mul_f32 v4, v3, v4
    v_accvgpr_write_b32 a30, v4
    v_accvgpr_read_b32 v4, a31
    v_mul_f32 v4, v3, v4
    v_accvgpr_write_b32 a31, v4
    v_accvgpr_read_b32 v4, a32
    v_mul_f32 v4, v3, v4
    v_accvgpr_write_b32 a32, v4
    v_accvgpr_read_b32 v4, a33
    v_mul_f32 v4, v3, v4
    v_accvgpr_write_b32 a33, v4
    v_accvgpr_read_b32 v4, a34
    v_mul_f32 v4, v3, v4
    v_accvgpr_write_b32 a34, v4
    v_accvgpr_read_b32 v4, a35
    v_mul_f32 v4, v3, v4
    v_accvgpr_write_b32 a35, v4
    v_accvgpr_read_b32 v4, a36
    v_mul_f32 v4, v3, v4
    v_accvgpr_write_b32 a36, v4
    v_accvgpr_read_b32 v4, a37
    v_mul_f32 v4, v3, v4
    v_accvgpr_write_b32 a37, v4
    v_accvgpr_read_b32 v4, a38
    v_mul_f32 v4, v3, v4
    v_accvgpr_write_b32 a38, v4
    v_accvgpr_read_b32 v4, a39
    v_mul_f32 v4, v3, v4
    v_accvgpr_write_b32 a39, v4
    v_accvgpr_read_b32 v4, a40
    v_mul_f32 v4, v3, v4
    v_accvgpr_write_b32 a40, v4
    v_accvgpr_read_b32 v4, a41
    v_mul_f32 v4, v3, v4
    v_accvgpr_write_b32 a41, v4
    v_accvgpr_read_b32 v4, a42
    v_mul_f32 v4, v3, v4
    v_accvgpr_write_b32 a42, v4
    v_accvgpr_read_b32 v4, a43
    v_mul_f32 v4, v3, v4
    v_accvgpr_write_b32 a43, v4
    v_accvgpr_read_b32 v4, a44
    v_mul_f32 v4, v3, v4
    v_accvgpr_write_b32 a44, v4
    v_accvgpr_read_b32 v4, a45
    v_mul_f32 v4, v3, v4
    v_accvgpr_write_b32 a45, v4
    v_accvgpr_read_b32 v4, a46
    v_mul_f32 v4, v3, v4
    v_accvgpr_write_b32 a46, v4
    v_accvgpr_read_b32 v4, a47
    v_mul_f32 v4, v3, v4
    v_accvgpr_write_b32 a47, v4
    v_accvgpr_read_b32 v4, a48
    v_mul_f32 v4, v3, v4
    v_accvgpr_write_b32 a48, v4
    v_accvgpr_read_b32 v4, a49
    v_mul_f32 v4, v3, v4
    v_accvgpr_write_b32 a49, v4
    v_accvgpr_read_b32 v4, a50
    v_mul_f32 v4, v3, v4
    v_accvgpr_write_b32 a50, v4
    v_accvgpr_read_b32 v4, a51
    v_mul_f32 v4, v3, v4
    v_accvgpr_write_b32 a51, v4
    v_accvgpr_read_b32 v4, a52
    v_mul_f32 v4, v3, v4
    v_accvgpr_write_b32 a52, v4
    v_accvgpr_read_b32 v4, a53
    v_mul_f32 v4, v3, v4
    v_accvgpr_write_b32 a53, v4
    v_accvgpr_read_b32 v4, a54
    v_mul_f32 v4, v3, v4
    v_accvgpr_write_b32 a54, v4
    v_accvgpr_read_b32 v4, a55
    v_mul_f32 v4, v3, v4
    v_accvgpr_write_b32 a55, v4
    v_accvgpr_read_b32 v4, a56
    v_mul_f32 v4, v3, v4
    v_accvgpr_write_b32 a56, v4
    v_accvgpr_read_b32 v4, a57
    v_mul_f32 v4, v3, v4
    v_accvgpr_write_b32 a57, v4
    v_accvgpr_read_b32 v4, a58
    v_mul_f32 v4, v3, v4
    v_accvgpr_write_b32 a58, v4
    v_accvgpr_read_b32 v4, a59
    v_mul_f32 v4, v3, v4
    v_accvgpr_write_b32 a59, v4
    v_accvgpr_read_b32 v4, a60
    v_mul_f32 v4, v3, v4
    v_accvgpr_write_b32 a60, v4
    v_accvgpr_read_b32 v4, a61
    v_mul_f32 v4, v3, v4
    v_accvgpr_write_b32 a61, v4
    v_accvgpr_read_b32 v4, a62
    v_mul_f32 v4, v3, v4
    v_accvgpr_write_b32 a62, v4
    v_accvgpr_read_b32 v4, a63
    v_mul_f32 v4, v3, v4
    v_accvgpr_write_b32 a63, v4
    v_lshlrev_b32 v4, 16, v72
    v_and_b32 v5, 0xffff0000, v72
    v_mul_f32 v4, v3, v4
    v_mul_f32 v5, v3, v5
    v_cvt_pk_bf16_f32 v72, v4, v5
    v_lshlrev_b32 v4, 16, v73
    v_and_b32 v5, 0xffff0000, v73
    v_mul_f32 v4, v3, v4
    v_mul_f32 v5, v3, v5
    v_cvt_pk_bf16_f32 v73, v4, v5
    v_lshlrev_b32 v4, 16, v74
    v_and_b32 v5, 0xffff0000, v74
    v_mul_f32 v4, v3, v4
    v_mul_f32 v5, v3, v5
    v_cvt_pk_bf16_f32 v74, v4, v5
    v_lshlrev_b32 v4, 16, v75
    v_and_b32 v5, 0xffff0000, v75
    v_mul_f32 v4, v3, v4
    v_mul_f32 v5, v3, v5
    v_cvt_pk_bf16_f32 v75, v4, v5
    v_lshlrev_b32 v4, 16, v76
    v_and_b32 v5, 0xffff0000, v76
    v_mul_f32 v4, v3, v4
    v_mul_f32 v5, v3, v5
    v_cvt_pk_bf16_f32 v76, v4, v5
    v_lshlrev_b32 v4, 16, v77
    v_and_b32 v5, 0xffff0000, v77
    v_mul_f32 v4, v3, v4
    v_mul_f32 v5, v3, v5
    v_cvt_pk_bf16_f32 v77, v4, v5
    v_lshlrev_b32 v4, 16, v78
    v_and_b32 v5, 0xffff0000, v78
    v_mul_f32 v4, v3, v4
    v_mul_f32 v5, v3, v5
    v_cvt_pk_bf16_f32 v78, v4, v5
    v_lshlrev_b32 v4, 16, v79
    v_and_b32 v5, 0xffff0000, v79
    v_mul_f32 v4, v3, v4
    v_mul_f32 v5, v3, v5
    v_cvt_pk_bf16_f32 v79, v4, v5
    v_mul_f32 v6, v3, v6
    s_nop 3
    s_setpc_b64 s[60:61]
L1_rare1:
    s_nop 15
    s_nop 15
    v_mov_b32 v3, v8
    s_nop 1
    v_permlane32_swap_b32 v8, v3
    s_nop 1
    v_max_f32 v8, v8, v3
    v_max_f32 v8, 0, v8
    v_sub_f32 v3, 0, v8
    v_exp_f32 v3, v3
    v_sub_f32 v48, v48, v8
    v_sub_f32 v80, v80, v8
    v_sub_f32 v49, v49, v8
    v_sub_f32 v81, v81, v8
    v_sub_f32 v50, v50, v8
    v_sub_f32 v82, v82, v8
    v_sub_f32 v51, v51, v8
    v_sub_f32 v83, v83, v8
    v_sub_f32 v52, v52, v8
    v_sub_f32 v84, v84, v8
    v_sub_f32 v53, v53, v8
    v_sub_f32 v85, v85, v8
    v_sub_f32 v54, v54, v8
    v_sub_f32 v86, v86, v8
    v_sub_f32 v55, v55, v8
    v_sub_f32 v87, v87, v8
    v_sub_f32 v56, v56, v8
    v_sub_f32 v88, v88, v8
    v_sub_f32 v57, v57, v8
    v_sub_f32 v89, v89, v8
    v_sub_f32 v58, v58, v8
    v_sub_f32 v90, v90, v8
    v_sub_f32 v59, v59, v8
    v_sub_f32 v91, v91, v8
    v_sub_f32 v60, v60, v8
    v_sub_f32 v92, v92, v8
    v_sub_f32 v61, v61, v8
    v_sub_f32 v93, v93, v8
    v_sub_f32 v62, v62, v8
    v_sub_f32 v94, v94, v8
    v_sub_f32 v63, v63, v8
    v_sub_f32 v95, v95, v8
    v_accvgpr_read_b32 v4, a0
    v_mul_f32 v4, v3, v4
    v_accvgpr_write_b32 a0, v4
    v_accvgpr_read_b32 v4, a1
    v_mul_f32 v4, v3, v4
    v_accvgpr_write_b32 a1, v4
    v_accvgpr_read_b32 v4, a2
    v_mul_f32 v4, v3, v4
    v_accvgpr_write_b32 a2, v4
    v_accvgpr_read_b32 v4, a3
    v_mul_f32 v4, v3, v4
    v_accvgpr_write_b32 a3, v4
    v_accvgpr_read_b32 v4, a4
    v_mul_f32 v4, v3, v4
    v_accvgpr_write_b32 a4, v4
    v_accvgpr_read_b32 v4, a5
    v_mul_f32 v4, v3, v4
    v_accvgpr_write_b32 a5, v4
    v_accvgpr_read_b32 v4, a6
    v_mul_f32 v4, v3, v4
    v_accvgpr_write_b32 a6, v4
    v_accvgpr_read_b32 v4, a7
    v_mul_f32 v4, v3, v4
    v_accvgpr_write_b32 a7, v4
    v_accvgpr_read_b32 v4, a8
    v_mul_f32 v4, v3, v4
    v_accvgpr_write_b32 a8, v4
    v_accvgpr_read_b32 v4, a9
    v_mul_f32 v4, v3, v4
    v_accvgpr_write_b32 a9, v4
    v_accvgpr_read_b32 v4, a10
    v_mul_f32 v4, v3, v4
    v_accvgpr_write_b32 a10, v4
    v_accvgpr_read_b32 v4, a11
    v_mul_f32 v4, v3, v4
    v_accvgpr_write_b32 a11, v4
    v_accvgpr_read_b32 v4, a12
    v_mul_f32 v4, v3, v4
    v_accvgpr_write_b32 a12, v4
    v_accvgpr_read_b32 v4, a13
    v_mul_f32 v4, v3, v4
    v_accvgpr_write_b32 a13, v4
    v_accvgpr_read_b32 v4, a14
    v_mul_f32 v4, v3, v4
    v_accvgpr_write_b32 a14, v4
    v_accvgpr_read_b32 v4, a15
    v_mul_f32 v4, v3, v4
    v_accvgpr_write_b32 a15, v4
    v_accvgpr_read_b32 v4, a16
    v_mul_f32 v4, v3, v4
    v_accvgpr_write_b32 a16, v4
    v_accvgpr_read_b32 v4, a17
    v_mul_f32 v4, v3, v4
    v_accvgpr_write_b32 a17, v4
    v_accvgpr_read_b32 v4, a18
    v_mul_f32 v4, v3, v4
    v_accvgpr_write_b32 a18, v4
    v_accvgpr_read_b32 v4, a19
    v_mul_f32 v4, v3, v4
    v_accvgpr_write_b32 a19, v4
    v_accvgpr_read_b32 v4, a20
    v_mul_f32 v4, v3, v4
    v_accvgpr_write_b32 a20, v4
    v_accvgpr_read_b32 v4, a21
    v_mul_f32 v4, v3, v4
    v_accvgpr_write_b32 a21, v4
    v_accvgpr_read_b32 v4, a22
    v_mul_f32 v4, v3, v4
    v_accvgpr_write_b32 a22, v4
    v_accvgpr_read_b32 v4, a23
    v_mul_f32 v4, v3, v4
    v_accvgpr_write_b32 a23, v4
    v_accvgpr_read_b32 v4, a24
    v_mul_f32 v4, v3, v4
    v_accvgpr_write_b32 a24, v4
    v_accvgpr_read_b32 v4, a25
    v_mul_f32 v4, v3, v4
    v_accvgpr_write_b32 a25, v4
    v_accvgpr_read_b32 v4, a26
    v_mul_f32 v4, v3, v4
    v_accvgpr_write_b32 a26, v4
    v_accvgpr_read_b32 v4, a27
    v_mul_f32 v4, v3, v4
    v_accvgpr_write_b32 a27, v4
    v_accvgpr_read_b32 v4, a28
    v_mul_f32 v4, v3, v4
    v_accvgpr_write_b32 a28, v4
    v_accvgpr_read_b32 v4, a29
    v_mul_f32 v4, v3, v4
    v_accvgpr_write_b32 a29, v4
    v_accvgpr_read_b32 v4, a30
    v_mul_f32 v4, v3, v4
    v_accvgpr_write_b32 a30, v4
    v_accvgpr_read_b32 v4, a31
    v_mul_f32 v4, v3, v4
    v_accvgpr_write_b32 a31, v4
    v_accvgpr_read_b32 v4, a32
    v_mul_f32 v4, v3, v4
    v_accvgpr_write_b32 a32, v4
    v_accvgpr_read_b32 v4, a33
    v_mul_f32 v4, v3, v4
    v_accvgpr_write_b32 a33, v4
    v_accvgpr_read_b32 v4, a34
    v_mul_f32 v4, v3, v4
    v_accvgpr_write_b32 a34, v4
    v_accvgpr_read_b32 v4, a35
    v_mul_f32 v4, v3, v4
    v_accvgpr_write_b32 a35, v4
    v_accvgpr_read_b32 v4, a36
    v_mul_f32 v4, v3, v4
    v_accvgpr_write_b32 a36, v4
    v_accvgpr_read_b32 v4, a37
    v_mul_f32 v4, v3, v4
    v_accvgpr_write_b32 a37, v4
    v_accvgpr_read_b32 v4, a38
    v_mul_f32 v4, v3, v4
    v_accvgpr_write_b32 a38, v4
    v_accvgpr_read_b32 v4, a39
    v_mul_f32 v4, v3, v4
    v_accvgpr_write_b32 a39, v4
    v_accvgpr_read_b32 v4, a40
    v_mul_f32 v4, v3, v4
    v_accvgpr_write_b32 a40, v4
    v_accvgpr_read_b32 v4, a41
    v_mul_f32 v4, v3, v4
    v_accvgpr_write_b32 a41, v4
    v_accvgpr_read_b32 v4, a42
    v_mul_f32 v4, v3, v4
    v_accvgpr_write_b32 a42, v4
    v_accvgpr_read_b32 v4, a43
    v_mul_f32 v4, v3, v4
    v_accvgpr_write_b32 a43, v4
    v_accvgpr_read_b32 v4, a44
    v_mul_f32 v4, v3, v4
    v_accvgpr_write_b32 a44, v4
    v_accvgpr_read_b32 v4, a45
    v_mul_f32 v4, v3, v4
    v_accvgpr_write_b32 a45, v4
    v_accvgpr_read_b32 v4, a46
    v_mul_f32 v4, v3, v4
    v_accvgpr_write_b32 a46, v4
    v_accvgpr_read_b32 v4, a47
    v_mul_f32 v4, v3, v4
    v_accvgpr_write_b32 a47, v4
    v_accvgpr_read_b32 v4, a48
    v_mul_f32 v4, v3, v4
    v_accvgpr_write_b32 a48, v4
    v_accvgpr_read_b32 v4, a49
    v_mul_f32 v4, v3, v4
    v_accvgpr_write_b32 a49, v4
    v_accvgpr_read_b32 v4, a50
    v_mul_f32 v4, v3, v4
    v_accvgpr_write_b32 a50, v4
    v_accvgpr_read_b32 v4, a51
    v_mul_f32 v4, v3, v4
    v_accvgpr_write_b32 a51, v4
    v_accvgpr_read_b32 v4, a52
    v_mul_f32 v4, v3, v4
    v_accvgpr_write_b32 a52, v4
    v_accvgpr_read_b32 v4, a53
    v_mul_f32 v4, v3, v4
    v_accvgpr_write_b32 a53, v4
    v_accvgpr_read_b32 v4, a54
    v_mul_f32 v4, v3, v4
    v_accvgpr_write_b32 a54, v4
    v_accvgpr_read_b32 v4, a55
    v_mul_f32 v4, v3, v4
    v_accvgpr_write_b32 a55, v4
    v_accvgpr_read_b32 v4, a56
    v_mul_f32 v4, v3, v4
    v_accvgpr_write_b32 a56, v4
    v_accvgpr_read_b32 v4, a57
    v_mul_f32 v4, v3, v4
    v_accvgpr_write_b32 a57, v4
    v_accvgpr_read_b32 v4, a58
    v_mul_f32 v4, v3, v4
    v_accvgpr_write_b32 a58, v4
    v_accvgpr_read_b32 v4, a59
    v_mul_f32 v4, v3, v4
    v_accvgpr_write_b32 a59, v4
    v_accvgpr_read_b32 v4, a60
    v_mul_f32 v4, v3, v4
    v_accvgpr_write_b32 a60, v4
    v_accvgpr_read_b32 v4, a61
    v_mul_f32 v4, v3, v4
    v_accvgpr_write_b32 a61, v4
    v_accvgpr_read_b32 v4, a62
    v_mul_f32 v4, v3, v4
    v_accvgpr_write_b32 a62, v4
    v_accvgpr_read_b32 v4, a63
    v_mul_f32 v4, v3, v4
    v_accvgpr_write_b32 a63, v4
    v_lshlrev_b32 v4, 16, v64
    v_and_b32 v5, 0xffff0000, v64
    v_mul_f32 v4, v3, v4
    v_mul_f32 v5, v3, v5
    v_cvt_pk_bf16_f32 v64, v4, v5
    v_lshlrev_b32 v4, 16, v65
    v_and_b32 v5, 0xffff0000, v65
    v_mul_f32 v4, v3, v4
    v_mul_f32 v5, v3, v5
    v_cvt_pk_bf16_f32 v65, v4, v5
    v_lshlrev_b32 v4, 16, v66
    v_and_b32 v5, 0xffff0000, v66
    v_mul_f32 v4, v3, v4
    v_mul_f32 v5, v3, v5
    v_cvt_pk_bf16_f32 v66, v4, v5
    v_lshlrev_b32 v4, 16, v67
    v_and_b32 v5, 0xffff0000, v67
    v_mul_f32 v4, v3, v4
    v_mul_f32 v5, v3, v5
    v_cvt_pk_bf16_f32 v67, v4, v5
    v_lshlrev_b32 v4, 16, v68
    v_and_b32 v5, 0xffff0000, v68
    v_mul_f32 v4, v3, v4
    v_mul_f32 v5, v3, v5
    v_cvt_pk_bf16_f32 v68, v4, v5
    v_lshlrev_b32 v4, 16, v69
    v_and_b32 v5, 0xffff0000, v69
    v_mul_f32 v4, v3, v4
    v_mul_f32 v5, v3, v5
    v_cvt_pk_bf16_f32 v69, v4, v5
    v_lshlrev_b32 v4, 16, v70
    v_and_b32 v5, 0xffff0000, v70
    v_mul_f32 v4, v3, v4
    v_mul_f32 v5, v3, v5
    v_cvt_pk_bf16_f32 v70, v4, v5
    v_lshlrev_b32 v4, 16, v71
    v_and_b32 v5, 0xffff0000, v71
    v_mul_f32 v4, v3, v4
    v_mul_f32 v5, v3, v5
    v_cvt_pk_bf16_f32 v71, v4, v5
    v_mul_f32 v6, v3, v6
    s_nop 3
    s_setpc_b64 s[60:61]
.section .rodata,"a"
.p2align 6
.amdhsa_kernel standalone__mha_block_cached__near_ridge_kernel
  .amdhsa_next_free_vgpr 256
  .amdhsa_next_free_sgpr 102
  .amdhsa_accum_offset 96
  .amdhsa_group_segment_fixed_size 0
  .amdhsa_kernarg_size 64
  .amdhsa_user_sgpr_count 2
  .amdhsa_user_sgpr_kernarg_segment_ptr 1
  .amdhsa_system_sgpr_workgroup_id_x 1
.end_amdhsa_kernel
```
